```python
import torch

def _softmax(x, axis=-1):
    return torch.softmax(x, dim=axis)
def _gelu(x):
    return torch.nn.functional.gelu(x, approximate="tanh")
def _silu(x):
    return torch.nn.functional.silu(x)
def _sigmoid(x):
    return torch.sigmoid(x)
def _layernorm(x, axis=-1, eps=1e-5):
    m = x.mean(dim=axis, keepdim=True)
    v = x.var(dim=axis, keepdim=True, unbiased=False)
    return (x - m) / torch.sqrt(v + eps)
def _scatter_add(tgt, idx, src, axis=0):
    return tgt.clone().index_add_(axis, idx, src)
def _segment_sum(src, seg, n):
    out = torch.zeros((n,) + src.shape[1:], dtype=src.dtype)
    return out.index_add_(0, seg, src)
def _pad(x, pw):
    flat = tuple(v for pair in reversed(pw) for v in pair)
    return torch.nn.functional.pad(x, flat)

kernel_name = 'gated_mix__spectral_gfnet__dense_activation_mish__prompt'

def setup_inputs():

    _w = (lambda a: (lambda t: t.to(torch.bfloat16) if t.is_floating_point() else t)(torch.as_tensor(a)))
    def _A_setup():
        B, S, D = 1, 2048, 512
        Df = D // 2 + 1
        return {
            "x": _w((lambda *s: torch.randn(*s, dtype=torch.bfloat16) * 0.05)(B, S, D)),
            "w_r": _w((lambda *s: torch.randn(*s, dtype=torch.bfloat16) * 1.6)(S, Df) * 0.02),
            "w_i": _w((lambda *s: torch.randn(*s, dtype=torch.bfloat16) * 1.6)(S, Df) * 0.02),
        }
    _A_in = _A_setup()

    def _B_setup():
        B, S, D, F = 1, 2048, 512, 1792
        return {
            "x": _w((lambda *s: torch.randn(*s, dtype=torch.bfloat16) * 0.05)(B, S, D)),
            "w1": _w((lambda *s: torch.randn(*s, dtype=torch.bfloat16) * 6.4)(D, F) * (D ** -0.5)),
            "b1": _w((lambda *s: torch.randn(*s, dtype=torch.bfloat16) * 0.05)(F)),
            "w2": _w((lambda *s: torch.randn(*s, dtype=torch.bfloat16) * 0.05)(F, D) * (F ** -0.5)),
        }
    _B_in = _B_setup()

    return {
        "A_x": _A_in["x"],
        "A_w_r": _A_in["w_r"],
        "A_w_i": _A_in["w_i"],
        "B_x": _B_in["x"],
        "B_w1": _B_in["w1"],
        "B_b1": _B_in["b1"],
        "B_w2": _B_in["w2"],
        "gate_w": _w((lambda *s: torch.randn(*s, dtype=torch.bfloat16) * 0.05)(512) * 16.0),
    }

def reference(A_x, A_w_r, A_w_i, B_x, B_w1, B_b1, B_w2, gate_w):
    def _A_ref(x, w_r, w_i):
        B, S, D = x.shape
        X = (lambda x, axes=(-2,-1): torch.fft.rfft2(x.float(), dim=axes))(x, axes=(-2, -1))
        W = w_r + 1j * w_i
        X = X * W
        y = (lambda x, s, axes=(-2,-1): torch.fft.irfft2(x, s=s, dim=axes).to(torch.bfloat16))(X, (S, D), axes=(-2, -1))
        return y

    def _B_ref(x, w1, b1, w2):
        h = torch.einsum("bsd,df->bsf", x, w1) + b1
        sp = torch.log1p(torch.exp(-torch.abs(h))) + torch.where(h > 0, h, torch.zeros_like(h))
        act = h * torch.tanh(sp)
        return torch.einsum("bsf,fd->bsd", act, w2)

    x = A_x
    g = _sigmoid((x * gate_w).sum(-1, keepdims=True))
    a = _A_ref(x, A_w_r, A_w_i)
    b = _B_ref(x, B_w1, B_b1, B_w2)
    return g * a + (1 - g) * b
```

```asm
; @launch grid=(512,1,1) block=(256,1,1) lds=81920
.amdgcn_target "amdgcn-amd-amdhsa--gfx950"
.text
.globl gated_mix__spectral_gfnet__dense_activation_mish__prompt_kernel
.p2align 8
.type gated_mix__spectral_gfnet__dense_activation_mish__prompt_kernel,@function
gated_mix__spectral_gfnet__dense_activation_mish__prompt_kernel:
    s_cmp_ge_u32 s2, 512
    s_cbranch_scc1 K_end
    s_cmp_lt_u32 s2, 256
    s_cbranch_scc1 K_roleF
    s_setprio 1
    s_load_dwordx2 s[56:57], s[0:1], 0
    s_load_dwordx2 s[58:59], s[0:1], 32
    s_load_dwordx4 s[60:63], s[0:1], 40
    s_load_dwordx2 s[64:65], s[0:1], 64
    s_load_dwordx2 s[66:67], s[0:1], 80
    s_and_b32 s3, s2, 255
    s_and_b32 s4, s3, 7
    s_lshr_b32 s5, s3, 3
    v_lshrrev_b32 v14, 6, v0
    v_and_b32 v1, 63, v0
    v_readfirstlane_b32 s6, v14
    s_mov_b32 s44, 0x3fb8aa3b
    s_mov_b32 s45, 0x3fb8aa3b
    s_load_dwordx4 s[96:99], s[0:1], 8
    s_lshr_b32 s38, s4, 1
    s_lshl_b32 s38, s38, 2
    s_and_b32 s39, s5, 3
    s_add_u32 s33, s38, s39
    s_and_b32 s38, s4, 1
    s_mul_i32 s38, s38, 7
    s_lshr_b32 s40, s5, 2
    s_add_u32 s34, s38, s40
    s_lshl_b32 s39, s39, 1
    s_add_u32 s35, s39, s40
    s_and_b32 s35, s35, 7
    s_lshl_b32 s38, s33, 7
    s_lshl_b32 s39, s6, 5
    s_add_u32 s38, s38, s39
    s_lshl_b32 s36, s38, 10
    s_lshl_b32 s38, s6, 4
    s_mul_i32 s38, s38, 3584
    s_lshl_b32 s39, s34, 8
    s_add_u32 s37, s38, s39
    s_lshl_b32 s55, s6, 12
    s_lshl_b32 s68, s6, 11
    v_lshrrev_b32 v15, 4, v1
    v_and_b32 v16, 7, v1
    v_xor_b32 v16, v16, v15
    v_lshlrev_b32 v16, 4, v16
    v_lshrrev_b32 v17, 3, v1
    v_mul_u32_u24 v17, 1024, v17
    v_add_u32 v2, v16, v17
    v_lshrrev_b32 v15, 4, v1
    v_add_u32 v15, 4, v15
    v_and_b32 v16, 7, v1
    v_xor_b32 v16, v16, v15
    v_lshlrev_b32 v16, 4, v16
    v_lshrrev_b32 v17, 3, v1
    v_mul_u32_u24 v17, 1024, v17
    v_add_u32 v3, v16, v17
    v_bfe_u32 v15, v1, 4, 1
    v_lshlrev_b32 v15, 2, v15
    v_and_b32 v16, 7, v1
    v_xor_b32 v16, v16, v15
    v_lshlrev_b32 v16, 4, v16
    v_lshrrev_b32 v17, 3, v1
    v_mul_u32_u24 v17, 3584, v17
    v_add_u32 v4, v16, v17
    s_waitcnt lgkmcnt(0)
    s_mov_b32 s8, s56
    s_and_b32 s9, s57, 0xffff
    s_mov_b32 s10, 2097152
    s_mov_b32 s11, 131072
    s_mov_b32 s12, s58
    s_and_b32 s13, s59, 0xffff
    s_mov_b32 s14, 1835008
    s_mov_b32 s15, 131072
    s_mov_b32 s24, s66
    s_and_b32 s25, s67, 0xffff
    s_mov_b32 s26, 268435456
    s_mov_b32 s27, 131072
    s_load_dword s32, s[66:67], 0
    s_lshl_b32 s73, s33, 4
    s_add_u32 s73, s73, s34
    s_mov_b32 s7, 0
    s_cmp_ge_u32 s5, 28
    s_cbranch_scc1 K_idleG1
    s_add_u32 s38, s35, 0
    s_and_b32 s38, s38, 7
    s_lshl_b32 s38, s38, 7
    s_add_u32 m0, s55, 0
    s_add_u32 s69, s36, s38
    buffer_load_dwordx4 v2, s[8:11], s69 offen offset:0  lds
    s_add_u32 m0, s55, 0
    s_add_u32 s69, s69, 7168
    buffer_load_dwordx4 v3, s[8:11], s69 offen offset:1024  lds
    s_add_u32 m0, s55, 0
    s_add_u32 s69, s69, 7168
    buffer_load_dwordx4 v2, s[8:11], s69 offen offset:2048  lds
    s_add_u32 m0, s55, 0
    s_add_u32 s69, s69, 7168
    buffer_load_dwordx4 v3, s[8:11], s69 offen offset:3072  lds
    s_add_u32 s38, s35, 0
    s_and_b32 s38, s38, 7
    s_mul_i32 s38, s38, 229376
    s_add_u32 m0, s68, 49152
    s_add_u32 s70, s37, s38
    buffer_load_dwordx4 v4, s[12:15], s70 offen  lds
    s_add_u32 m0, s68, 49152
    s_add_u32 s70, s70, 27648
    buffer_load_dwordx4 v4, s[12:15], s70 offen offset:1024  lds
    s_add_u32 s38, s35, 1
    s_and_b32 s38, s38, 7
    s_mul_i32 s38, s38, 229376
    s_add_u32 m0, s68, 57344
    s_add_u32 s70, s37, s38
    buffer_load_dwordx4 v4, s[12:15], s70 offen  lds
    s_add_u32 m0, s68, 57344
    s_add_u32 s70, s70, 27648
    buffer_load_dwordx4 v4, s[12:15], s70 offen offset:1024  lds
    s_mov_b32 s16, s60
    s_and_b32 s17, s61, 0xffff
    s_mov_b32 s18, 3584
    s_mov_b32 s19, 131072
    s_mov_b32 s20, s62
    s_and_b32 s21, s63, 0xffff
    s_mov_b32 s22, 1835008
    s_mov_b32 s23, 131072
    s_mov_b32 s28, s64
    s_and_b32 s29, s65, 0xffff
    s_mov_b32 s30, 2097152
    s_mov_b32 s31, 131072
    v_and_b32 v14, 31, v1
    v_lshlrev_b32 v14, 1, v14
    s_lshl_b32 s38, s34, 8
    v_add_u32 v14, s38, v14
    v_mov_b32 v15, 0x7ff00000
    v_cmp_gt_u32 vcc, 32, v1
    s_nop 1
    v_cndmask_b32 v14, v15, v14, vcc
    buffer_load_ushort v48, v14, s[16:19], 0 offen offset:0
    buffer_load_ushort v52, v14, s[16:19], 0 offen offset:64
    buffer_load_ushort v56, v14, s[16:19], 0 offen offset:128
    buffer_load_ushort v60, v14, s[16:19], 0 offen offset:192
    s_add_u32 s38, s35, 1
    s_and_b32 s38, s38, 7
    s_lshl_b32 s38, s38, 7
    s_add_u32 m0, s55, 16384
    s_add_u32 s69, s36, s38
    buffer_load_dwordx4 v2, s[8:11], s69 offen offset:0  lds
    s_add_u32 m0, s55, 16384
    s_add_u32 s69, s69, 7168
    buffer_load_dwordx4 v3, s[8:11], s69 offen offset:1024  lds
    s_add_u32 m0, s55, 16384
    s_add_u32 s69, s69, 7168
    buffer_load_dwordx4 v2, s[8:11], s69 offen offset:2048  lds
    s_add_u32 m0, s55, 16384
    s_add_u32 s69, s69, 7168
    buffer_load_dwordx4 v3, s[8:11], s69 offen offset:3072  lds
    s_add_u32 s38, s35, 2
    s_and_b32 s38, s38, 7
    s_mul_i32 s38, s38, 229376
    s_add_u32 m0, s68, 65536
    s_add_u32 s70, s37, s38
    buffer_load_dwordx4 v4, s[12:15], s70 offen  lds
    s_add_u32 m0, s68, 65536
    s_add_u32 s70, s70, 27648
    buffer_load_dwordx4 v4, s[12:15], s70 offen offset:1024  lds
    s_add_u32 s38, s35, 2
    s_and_b32 s38, s38, 7
    s_lshl_b32 s38, s38, 7
    s_add_u32 m0, s55, 32768
    s_add_u32 s69, s36, s38
    buffer_load_dwordx4 v2, s[8:11], s69 offen offset:0  lds
    s_add_u32 m0, s55, 32768
    s_add_u32 s69, s69, 7168
    buffer_load_dwordx4 v3, s[8:11], s69 offen offset:1024  lds
    s_add_u32 m0, s55, 32768
    s_add_u32 s69, s69, 7168
    buffer_load_dwordx4 v2, s[8:11], s69 offen offset:2048  lds
    s_add_u32 m0, s55, 32768
    s_add_u32 s69, s69, 7168
    buffer_load_dwordx4 v3, s[8:11], s69 offen offset:3072  lds
    v_mov_b32 v49, 0
    v_mov_b32 v50, 0
    v_mov_b32 v51, 0
    v_mov_b32 v53, 0
    v_mov_b32 v54, 0
    v_mov_b32 v55, 0
    v_mov_b32 v57, 0
    v_mov_b32 v58, 0
    v_mov_b32 v59, 0
    v_mov_b32 v61, 0
    v_mov_b32 v62, 0
    v_mov_b32 v63, 0
    v_mov_b32 v44, 0x3f80
    v_mov_b32 v45, 0
    v_mov_b32 v46, 0
    v_mov_b32 v47, 0
    v_and_b32 v14, 31, v1
    v_lshrrev_b32 v15, 5, v1
    v_bfe_u32 v16, v14, 1, 3
    v_lshlrev_b32 v14, 7, v14
    v_add_u32 v14, s55, v14
    v_add_u32 v17, 0, v15
    v_xor_b32 v17, v17, v16
    v_lshl_add_u32 v5, v17, 4, v14
    v_add_u32 v17, 2, v15
    v_xor_b32 v17, v17, v16
    v_lshl_add_u32 v6, v17, 4, v14
    v_add_u32 v17, 4, v15
    v_xor_b32 v17, v17, v16
    v_lshl_add_u32 v7, v17, 4, v14
    v_add_u32 v17, 6, v15
    v_xor_b32 v17, v17, v16
    v_lshl_add_u32 v8, v17, 4, v14
    v_lshrrev_b32 v14, 5, v1
    v_lshlrev_b32 v14, 3, v14
    v_bfe_u32 v15, v1, 2, 2
    v_add_u32 v14, v14, v15
    v_lshlrev_b32 v14, 7, v14
    v_bfe_u32 v15, v1, 3, 1
    v_xor_b32 v15, 0, v15
    v_lshl_add_u32 v14, v15, 6, v14
    v_bfe_u32 v15, v1, 4, 1
    v_lshl_add_u32 v14, v15, 5, v14
    v_and_b32 v15, 3, v1
    v_lshl_add_u32 v14, v15, 3, v14
    v_add_u32 v9, 49152, v14
    v_lshrrev_b32 v14, 5, v1
    v_lshlrev_b32 v14, 3, v14
    v_bfe_u32 v15, v1, 2, 2
    v_add_u32 v14, v14, v15
    v_lshlrev_b32 v14, 7, v14
    v_bfe_u32 v15, v1, 3, 1
    v_xor_b32 v15, 1, v15
    v_lshl_add_u32 v14, v15, 6, v14
    v_bfe_u32 v15, v1, 4, 1
    v_lshl_add_u32 v14, v15, 5, v14
    v_and_b32 v15, 3, v1
    v_lshl_add_u32 v14, v15, 3, v14
    v_add_u32 v10, 49152, v14
    v_and_b32 v14, 31, v1
    v_and_b32 v15, 7, v14
    v_lshlrev_b32 v15, 4, v15
    v_lshl_add_u32 v15, v14, 7, v15
    v_lshrrev_b32 v14, 5, v1
    v_lshl_add_u32 v15, v14, 3, v15
    v_add_u32 v11, s55, v15
    v_lshrrev_b32 v14, 3, v1
    v_and_b32 v15, 7, v1
    v_xor_b32 v15, v15, v14
    v_lshlrev_b32 v15, 4, v15
    v_lshl_add_u32 v15, v14, 7, v15
    v_add_u32 v12, s55, v15
    v_lshlrev_b32 v13, 4, v1
    s_waitcnt vmcnt(16)
    s_barrier
    ds_read_b128 v[128:131], v5 offset:0
    ds_read_b128 v[132:135], v6 offset:0
    ds_read_b128 v[136:139], v7 offset:0
    ds_read_b128 v[140:143], v8 offset:0
    s_waitcnt vmcnt(10)
    v_mfma_f32_32x32x16_bf16 v[64:79], v[48:51], v[44:47], 0
    v_mfma_f32_32x32x16_bf16 v[80:95], v[52:55], v[44:47], 0
    v_mfma_f32_32x32x16_bf16 v[96:111], v[56:59], v[44:47], 0
    v_mfma_f32_32x32x16_bf16 v[112:127], v[60:63], v[44:47], 0
    ds_read_b64_tr_b16 v[16:17], v9 offset:0
    ds_read_b64_tr_b16 v[18:19], v9 offset:512
    ds_read_b64_tr_b16 v[20:21], v10 offset:0
    ds_read_b64_tr_b16 v[22:23], v10 offset:512
    ds_read_b64_tr_b16 v[24:25], v9 offset:2048
    ds_read_b64_tr_b16 v[26:27], v9 offset:2560
    ds_read_b64_tr_b16 v[28:29], v10 offset:2048
    ds_read_b64_tr_b16 v[30:31], v10 offset:2560
    ds_read_b64_tr_b16 v[32:33], v9 offset:4096
    ds_read_b64_tr_b16 v[34:35], v9 offset:4608
    ds_read_b64_tr_b16 v[36:37], v10 offset:4096
    ds_read_b64_tr_b16 v[38:39], v10 offset:4608
    ds_read_b64_tr_b16 v[40:41], v9 offset:6144
    ds_read_b64_tr_b16 v[42:43], v9 offset:6656
    ds_read_b64_tr_b16 v[44:45], v10 offset:6144
    ds_read_b64_tr_b16 v[46:47], v10 offset:6656
    s_waitcnt lgkmcnt(15)
    s_waitcnt vmcnt(6)
    s_barrier
    s_waitcnt lgkmcnt(12)
    v_mfma_f32_32x32x16_bf16 v[64:79], v[16:19], v[128:131], v[64:79]
    ds_read_b128 v[144:147], v5 offset:16384
    ds_read_b128 v[148:151], v6 offset:16384
    ds_read_b128 v[152:155], v7 offset:16384
    ds_read_b128 v[156:159], v8 offset:16384
    s_add_u32 s38, s35, 3
    s_and_b32 s38, s38, 7
    s_mul_i32 s38, s38, 229376
    s_add_u32 m0, s68, 73728
    s_add_u32 s70, s37, s38
    buffer_load_dwordx4 v4, s[12:15], s70 offen  lds
    v_mfma_f32_32x32x16_bf16 v[80:95], v[20:23], v[128:131], v[80:95]
    ds_read_b64_tr_b16 v[16:17], v9 offset:8192
    ds_read_b64_tr_b16 v[18:19], v9 offset:8704
    s_add_u32 m0, s68, 73728
    s_add_u32 s70, s70, 27648
    buffer_load_dwordx4 v4, s[12:15], s70 offen offset:1024  lds
    s_waitcnt lgkmcnt(14)
    v_mfma_f32_32x32x16_bf16 v[64:79], v[24:27], v[132:135], v[64:79]
    ds_read_b64_tr_b16 v[20:21], v10 offset:8192
    ds_read_b64_tr_b16 v[22:23], v10 offset:8704
    s_add_u32 s38, s35, 3
    s_and_b32 s38, s38, 7
    s_lshl_b32 s38, s38, 7
    s_add_u32 m0, s55, 0
    s_add_u32 s69, s36, s38
    buffer_load_dwordx4 v2, s[8:11], s69 offen offset:0  lds
    v_mfma_f32_32x32x16_bf16 v[80:95], v[28:31], v[132:135], v[80:95]
    ds_read_b64_tr_b16 v[24:25], v9 offset:10240
    ds_read_b64_tr_b16 v[26:27], v9 offset:10752
    s_waitcnt lgkmcnt(6)
    s_add_u32 m0, s55, 0
    s_add_u32 s69, s69, 7168
    buffer_load_dwordx4 v3, s[8:11], s69 offen offset:1024  lds
    v_mfma_f32_32x32x16_bf16 v[64:79], v[32:35], v[136:139], v[64:79]
    ds_read_b64_tr_b16 v[28:29], v10 offset:10240
    ds_read_b64_tr_b16 v[30:31], v10 offset:10752
    s_add_u32 m0, s55, 0
    s_add_u32 s69, s69, 7168
    buffer_load_dwordx4 v2, s[8:11], s69 offen offset:2048  lds
    v_mfma_f32_32x32x16_bf16 v[80:95], v[36:39], v[136:139], v[80:95]
    ds_read_b64_tr_b16 v[32:33], v9 offset:12288
    ds_read_b64_tr_b16 v[34:35], v9 offset:12800
    s_add_u32 m0, s55, 0
    s_add_u32 s69, s69, 7168
    buffer_load_dwordx4 v3, s[8:11], s69 offen offset:3072  lds
    v_mfma_f32_32x32x16_bf16 v[64:79], v[40:43], v[140:143], v[64:79]
    ds_read_b64_tr_b16 v[36:37], v10 offset:12288
    ds_read_b64_tr_b16 v[38:39], v10 offset:12800
    s_add_u32 s38, s35, 4
    s_and_b32 s38, s38, 7
    s_lshl_b32 s38, s38, 7
    s_add_u32 m0, s55, 16384
    s_add_u32 s69, s36, s38
    buffer_load_dwordx4 v2, s[8:11], s69 offen offset:0  lds
    v_mfma_f32_32x32x16_bf16 v[80:95], v[44:47], v[140:143], v[80:95]
    ds_read_b64_tr_b16 v[40:41], v9 offset:14336
    ds_read_b64_tr_b16 v[42:43], v9 offset:14848
    s_add_u32 m0, s55, 16384
    s_add_u32 s69, s69, 7168
    buffer_load_dwordx4 v3, s[8:11], s69 offen offset:1024  lds
    s_waitcnt vmcnt(8)
    s_barrier
    s_waitcnt lgkmcnt(10)
    v_mfma_f32_32x32x16_bf16 v[64:79], v[16:19], v[144:147], v[64:79]
    ds_read_b64_tr_b16 v[44:45], v10 offset:14336
    ds_read_b64_tr_b16 v[46:47], v10 offset:14848
    ds_read_b128 v[160:163], v5 offset:32768
    ds_read_b128 v[164:167], v6 offset:32768
    ds_read_b128 v[168:171], v7 offset:32768
    ds_read_b128 v[172:175], v8 offset:32768
    s_add_u32 s38, s35, 4
    s_and_b32 s38, s38, 7
    s_mul_i32 s38, s38, 229376
    s_add_u32 m0, s68, 49152
    s_add_u32 s70, s37, s38
    buffer_load_dwordx4 v4, s[12:15], s70 offen  lds
    v_mfma_f32_32x32x16_bf16 v[80:95], v[20:23], v[144:147], v[80:95]
    ds_read_b64_tr_b16 v[16:17], v9 offset:16384
    ds_read_b64_tr_b16 v[18:19], v9 offset:16896
    s_add_u32 m0, s68, 49152
    s_add_u32 s70, s70, 27648
    buffer_load_dwordx4 v4, s[12:15], s70 offen offset:1024  lds
    s_waitcnt lgkmcnt(14)
    v_mfma_f32_32x32x16_bf16 v[64:79], v[24:27], v[148:151], v[64:79]
    ds_read_b64_tr_b16 v[20:21], v10 offset:16384
    ds_read_b64_tr_b16 v[22:23], v10 offset:16896
    s_add_u32 m0, s55, 16384
    s_add_u32 s69, s69, 7168
    buffer_load_dwordx4 v2, s[8:11], s69 offen offset:2048  lds
    v_mfma_f32_32x32x16_bf16 v[80:95], v[28:31], v[148:151], v[80:95]
    ds_read_b64_tr_b16 v[24:25], v9 offset:18432
    ds_read_b64_tr_b16 v[26:27], v9 offset:18944
    s_waitcnt lgkmcnt(6)
    s_add_u32 m0, s55, 16384
    s_add_u32 s69, s69, 7168
    buffer_load_dwordx4 v3, s[8:11], s69 offen offset:3072  lds
    v_mfma_f32_32x32x16_bf16 v[64:79], v[32:35], v[152:155], v[64:79]
    ds_read_b64_tr_b16 v[28:29], v10 offset:18432
    ds_read_b64_tr_b16 v[30:31], v10 offset:18944
    s_add_u32 s38, s35, 5
    s_and_b32 s38, s38, 7
    s_lshl_b32 s38, s38, 7
    s_add_u32 m0, s55, 32768
    s_add_u32 s69, s36, s38
    buffer_load_dwordx4 v2, s[8:11], s69 offen offset:0  lds
    v_mfma_f32_32x32x16_bf16 v[80:95], v[36:39], v[152:155], v[80:95]
    ds_read_b64_tr_b16 v[32:33], v9 offset:20480
    ds_read_b64_tr_b16 v[34:35], v9 offset:20992
    s_add_u32 m0, s55, 32768
    s_add_u32 s69, s69, 7168
    buffer_load_dwordx4 v3, s[8:11], s69 offen offset:1024  lds
    v_mfma_f32_32x32x16_bf16 v[64:79], v[40:43], v[156:159], v[64:79]
    ds_read_b64_tr_b16 v[36:37], v10 offset:20480
    ds_read_b64_tr_b16 v[38:39], v10 offset:20992
    s_add_u32 m0, s55, 32768
    s_add_u32 s69, s69, 7168
    buffer_load_dwordx4 v2, s[8:11], s69 offen offset:2048  lds
    v_mfma_f32_32x32x16_bf16 v[80:95], v[44:47], v[156:159], v[80:95]
    ds_read_b64_tr_b16 v[40:41], v9 offset:22528
    ds_read_b64_tr_b16 v[42:43], v9 offset:23040
    s_add_u32 m0, s55, 32768
    s_add_u32 s69, s69, 7168
    buffer_load_dwordx4 v3, s[8:11], s69 offen offset:3072  lds
    s_waitcnt vmcnt(10)
    s_barrier
    s_waitcnt lgkmcnt(10)
    v_mfma_f32_32x32x16_bf16 v[64:79], v[16:19], v[160:163], v[64:79]
    ds_read_b64_tr_b16 v[44:45], v10 offset:22528
    ds_read_b64_tr_b16 v[46:47], v10 offset:23040
    ds_read_b128 v[176:179], v5 offset:0
    ds_read_b128 v[180:183], v6 offset:0
    ds_read_b128 v[184:187], v7 offset:0
    ds_read_b128 v[188:191], v8 offset:0
    s_add_u32 s38, s35, 5
    s_and_b32 s38, s38, 7
    s_mul_i32 s38, s38, 229376
    s_add_u32 m0, s68, 57344
    s_add_u32 s70, s37, s38
    buffer_load_dwordx4 v4, s[12:15], s70 offen  lds
    v_mfma_f32_32x32x16_bf16 v[80:95], v[20:23], v[160:163], v[80:95]
    ds_read_b64_tr_b16 v[16:17], v9 offset:24576
    ds_read_b64_tr_b16 v[18:19], v9 offset:25088
    s_add_u32 m0, s68, 57344
    s_add_u32 s70, s70, 27648
    buffer_load_dwordx4 v4, s[12:15], s70 offen offset:1024  lds
    s_waitcnt lgkmcnt(14)
    v_mfma_f32_32x32x16_bf16 v[64:79], v[24:27], v[164:167], v[64:79]
    ds_read_b64_tr_b16 v[20:21], v10 offset:24576
    ds_read_b64_tr_b16 v[22:23], v10 offset:25088
    v_mfma_f32_32x32x16_bf16 v[80:95], v[28:31], v[164:167], v[80:95]
    ds_read_b64_tr_b16 v[24:25], v9 offset:26624
    ds_read_b64_tr_b16 v[26:27], v9 offset:27136
    s_waitcnt lgkmcnt(6)
    s_add_u32 s38, s35, 6
    s_and_b32 s38, s38, 7
    s_lshl_b32 s38, s38, 7
    s_add_u32 m0, s55, 0
    s_add_u32 s69, s36, s38
    buffer_load_dwordx4 v2, s[8:11], s69 offen offset:0  lds
    v_mfma_f32_32x32x16_bf16 v[64:79], v[32:35], v[168:171], v[64:79]
    ds_read_b64_tr_b16 v[28:29], v10 offset:26624
    ds_read_b64_tr_b16 v[30:31], v10 offset:27136
    s_add_u32 m0, s55, 0
    s_add_u32 s69, s69, 7168
    buffer_load_dwordx4 v3, s[8:11], s69 offen offset:1024  lds
    v_mfma_f32_32x32x16_bf16 v[80:95], v[36:39], v[168:171], v[80:95]
    ds_read_b64_tr_b16 v[32:33], v9 offset:28672
    ds_read_b64_tr_b16 v[34:35], v9 offset:29184
    s_add_u32 m0, s55, 0
    s_add_u32 s69, s69, 7168
    buffer_load_dwordx4 v2, s[8:11], s69 offen offset:2048  lds
    v_mfma_f32_32x32x16_bf16 v[64:79], v[40:43], v[172:175], v[64:79]
    ds_read_b64_tr_b16 v[36:37], v10 offset:28672
    ds_read_b64_tr_b16 v[38:39], v10 offset:29184
    s_add_u32 m0, s55, 0
    s_add_u32 s69, s69, 7168
    buffer_load_dwordx4 v3, s[8:11], s69 offen offset:3072  lds
    v_mfma_f32_32x32x16_bf16 v[80:95], v[44:47], v[172:175], v[80:95]
    ds_read_b64_tr_b16 v[40:41], v9 offset:30720
    ds_read_b64_tr_b16 v[42:43], v9 offset:31232
    s_waitcnt vmcnt(10)
    s_barrier
    s_waitcnt lgkmcnt(10)
    v_mfma_f32_32x32x16_bf16 v[64:79], v[16:19], v[176:179], v[64:79]
    ds_read_b64_tr_b16 v[44:45], v10 offset:30720
    ds_read_b64_tr_b16 v[46:47], v10 offset:31232
    ds_read_b128 v[192:195], v5 offset:16384
    ds_read_b128 v[196:199], v6 offset:16384
    ds_read_b128 v[200:203], v7 offset:16384
    ds_read_b128 v[204:207], v8 offset:16384
    s_add_u32 s38, s35, 6
    s_and_b32 s38, s38, 7
    s_mul_i32 s38, s38, 229376
    s_add_u32 m0, s68, 65536
    s_add_u32 s70, s37, s38
    buffer_load_dwordx4 v4, s[12:15], s70 offen  lds
    v_mfma_f32_32x32x16_bf16 v[80:95], v[20:23], v[176:179], v[80:95]
    ds_read_b64_tr_b16 v[16:17], v9 offset:0
    ds_read_b64_tr_b16 v[18:19], v9 offset:512
    s_add_u32 m0, s68, 65536
    s_add_u32 s70, s70, 27648
    buffer_load_dwordx4 v4, s[12:15], s70 offen offset:1024  lds
    s_waitcnt lgkmcnt(14)
    v_mfma_f32_32x32x16_bf16 v[64:79], v[24:27], v[180:183], v[64:79]
    ds_read_b64_tr_b16 v[20:21], v10 offset:0
    ds_read_b64_tr_b16 v[22:23], v10 offset:512
    v_mfma_f32_32x32x16_bf16 v[80:95], v[28:31], v[180:183], v[80:95]
    ds_read_b64_tr_b16 v[24:25], v9 offset:2048
    ds_read_b64_tr_b16 v[26:27], v9 offset:2560
    s_waitcnt lgkmcnt(6)
    s_add_u32 s38, s35, 7
    s_and_b32 s38, s38, 7
    s_lshl_b32 s38, s38, 7
    s_add_u32 m0, s55, 16384
    s_add_u32 s69, s36, s38
    buffer_load_dwordx4 v2, s[8:11], s69 offen offset:0  lds
    v_mfma_f32_32x32x16_bf16 v[64:79], v[32:35], v[184:187], v[64:79]
    ds_read_b64_tr_b16 v[28:29], v10 offset:2048
    ds_read_b64_tr_b16 v[30:31], v10 offset:2560
    s_add_u32 m0, s55, 16384
    s_add_u32 s69, s69, 7168
    buffer_load_dwordx4 v3, s[8:11], s69 offen offset:1024  lds
    v_mfma_f32_32x32x16_bf16 v[80:95], v[36:39], v[184:187], v[80:95]
    ds_read_b64_tr_b16 v[32:33], v9 offset:4096
    ds_read_b64_tr_b16 v[34:35], v9 offset:4608
    s_add_u32 m0, s55, 16384
    s_add_u32 s69, s69, 7168
    buffer_load_dwordx4 v2, s[8:11], s69 offen offset:2048  lds
    v_mfma_f32_32x32x16_bf16 v[64:79], v[40:43], v[188:191], v[64:79]
    ds_read_b64_tr_b16 v[36:37], v10 offset:4096
    ds_read_b64_tr_b16 v[38:39], v10 offset:4608
    s_add_u32 m0, s55, 16384
    s_add_u32 s69, s69, 7168
    buffer_load_dwordx4 v3, s[8:11], s69 offen offset:3072  lds
    v_mfma_f32_32x32x16_bf16 v[80:95], v[44:47], v[188:191], v[80:95]
    ds_read_b64_tr_b16 v[40:41], v9 offset:6144
    ds_read_b64_tr_b16 v[42:43], v9 offset:6656
    s_waitcnt vmcnt(10)
    s_barrier
    s_waitcnt lgkmcnt(10)
    v_mfma_f32_32x32x16_bf16 v[64:79], v[16:19], v[192:195], v[64:79]
    ds_read_b64_tr_b16 v[44:45], v10 offset:6144
    ds_read_b64_tr_b16 v[46:47], v10 offset:6656
    ds_read_b128 v[208:211], v5 offset:32768
    ds_read_b128 v[212:215], v6 offset:32768
    ds_read_b128 v[216:219], v7 offset:32768
    ds_read_b128 v[220:223], v8 offset:32768
    s_add_u32 s38, s35, 7
    s_and_b32 s38, s38, 7
    s_mul_i32 s38, s38, 229376
    s_add_u32 m0, s68, 73728
    s_add_u32 s70, s37, s38
    buffer_load_dwordx4 v4, s[12:15], s70 offen  lds
    v_mfma_f32_32x32x16_bf16 v[80:95], v[20:23], v[192:195], v[80:95]
    ds_read_b64_tr_b16 v[16:17], v9 offset:8192
    ds_read_b64_tr_b16 v[18:19], v9 offset:8704
    s_add_u32 m0, s68, 73728
    s_add_u32 s70, s70, 27648
    buffer_load_dwordx4 v4, s[12:15], s70 offen offset:1024  lds
    s_waitcnt lgkmcnt(14)
    v_mfma_f32_32x32x16_bf16 v[64:79], v[24:27], v[196:199], v[64:79]
    ds_read_b64_tr_b16 v[20:21], v10 offset:8192
    ds_read_b64_tr_b16 v[22:23], v10 offset:8704
    v_mfma_f32_32x32x16_bf16 v[80:95], v[28:31], v[196:199], v[80:95]
    ds_read_b64_tr_b16 v[24:25], v9 offset:10240
    ds_read_b64_tr_b16 v[26:27], v9 offset:10752
    s_waitcnt lgkmcnt(14)
    v_mfma_f32_32x32x16_bf16 v[64:79], v[32:35], v[200:203], v[64:79]
    ds_read_b64_tr_b16 v[28:29], v10 offset:10240
    ds_read_b64_tr_b16 v[30:31], v10 offset:10752
    v_mfma_f32_32x32x16_bf16 v[80:95], v[36:39], v[200:203], v[80:95]
    ds_read_b64_tr_b16 v[32:33], v9 offset:12288
    ds_read_b64_tr_b16 v[34:35], v9 offset:12800
    s_waitcnt lgkmcnt(14)
    v_mfma_f32_32x32x16_bf16 v[64:79], v[40:43], v[204:207], v[64:79]
    ds_read_b64_tr_b16 v[36:37], v10 offset:12288
    ds_read_b64_tr_b16 v[38:39], v10 offset:12800
    v_mfma_f32_32x32x16_bf16 v[80:95], v[44:47], v[204:207], v[80:95]
    ds_read_b64_tr_b16 v[40:41], v9 offset:14336
    ds_read_b64_tr_b16 v[42:43], v9 offset:14848
    s_waitcnt vmcnt(6)
    s_barrier
    s_waitcnt lgkmcnt(10)
    v_mfma_f32_32x32x16_bf16 v[64:79], v[16:19], v[208:211], v[64:79]
    ds_read_b64_tr_b16 v[44:45], v10 offset:14336
    ds_read_b64_tr_b16 v[46:47], v10 offset:14848
    ds_read_b128 v[224:227], v5 offset:0
    ds_read_b128 v[228:231], v6 offset:0
    ds_read_b128 v[232:235], v7 offset:0
    ds_read_b128 v[236:239], v8 offset:0
    s_add_u32 s38, s35, 0
    s_and_b32 s38, s38, 7
    s_mul_i32 s38, s38, 229376
    s_add_u32 s70, s37, s38
    s_add_u32 m0, s68, 49152
    s_add_u32 s70, s70, 128
    buffer_load_dwordx4 v4, s[12:15], s70 offen  lds
    v_mfma_f32_32x32x16_bf16 v[80:95], v[20:23], v[208:211], v[80:95]
    ds_read_b64_tr_b16 v[16:17], v9 offset:16384
    ds_read_b64_tr_b16 v[18:19], v9 offset:16896
    s_add_u32 m0, s68, 49152
    s_add_u32 s70, s70, 27648
    buffer_load_dwordx4 v4, s[12:15], s70 offen offset:1024  lds
    s_waitcnt lgkmcnt(14)
    v_mfma_f32_32x32x16_bf16 v[64:79], v[24:27], v[212:215], v[64:79]
    ds_read_b64_tr_b16 v[20:21], v10 offset:16384
    ds_read_b64_tr_b16 v[22:23], v10 offset:16896
    v_mfma_f32_32x32x16_bf16 v[80:95], v[28:31], v[212:215], v[80:95]
    ds_read_b64_tr_b16 v[24:25], v9 offset:18432
    ds_read_b64_tr_b16 v[26:27], v9 offset:18944
    s_waitcnt lgkmcnt(14)
    v_mfma_f32_32x32x16_bf16 v[64:79], v[32:35], v[216:219], v[64:79]
    ds_read_b64_tr_b16 v[28:29], v10 offset:18432
    ds_read_b64_tr_b16 v[30:31], v10 offset:18944
    v_mfma_f32_32x32x16_bf16 v[80:95], v[36:39], v[216:219], v[80:95]
    ds_read_b64_tr_b16 v[32:33], v9 offset:20480
    ds_read_b64_tr_b16 v[34:35], v9 offset:20992
    s_waitcnt lgkmcnt(14)
    v_mfma_f32_32x32x16_bf16 v[64:79], v[40:43], v[220:223], v[64:79]
    ds_read_b64_tr_b16 v[36:37], v10 offset:20480
    ds_read_b64_tr_b16 v[38:39], v10 offset:20992
    v_mfma_f32_32x32x16_bf16 v[80:95], v[44:47], v[220:223], v[80:95]
    ds_read_b64_tr_b16 v[40:41], v9 offset:22528
    ds_read_b64_tr_b16 v[42:43], v9 offset:23040
    s_waitcnt vmcnt(2)
    s_barrier
    s_waitcnt lgkmcnt(10)
    v_mfma_f32_32x32x16_bf16 v[64:79], v[16:19], v[224:227], v[64:79]
    ds_read_b64_tr_b16 v[44:45], v10 offset:22528
    ds_read_b64_tr_b16 v[46:47], v10 offset:23040
    ds_read_b128 v[240:243], v5 offset:16384
    ds_read_b128 v[244:247], v6 offset:16384
    ds_read_b128 v[248:251], v7 offset:16384
    ds_read_b128 v[252:255], v8 offset:16384
    s_add_u32 s38, s35, 1
    s_and_b32 s38, s38, 7
    s_mul_i32 s38, s38, 229376
    s_add_u32 s70, s37, s38
    s_add_u32 m0, s68, 57344
    s_add_u32 s70, s70, 128
    buffer_load_dwordx4 v4, s[12:15], s70 offen  lds
    v_mfma_f32_32x32x16_bf16 v[80:95], v[20:23], v[224:227], v[80:95]
    ds_read_b64_tr_b16 v[16:17], v9 offset:24576
    ds_read_b64_tr_b16 v[18:19], v9 offset:25088
    s_add_u32 m0, s68, 57344
    s_add_u32 s70, s70, 27648
    buffer_load_dwordx4 v4, s[12:15], s70 offen offset:1024  lds
    s_waitcnt lgkmcnt(14)
    v_mfma_f32_32x32x16_bf16 v[64:79], v[24:27], v[228:231], v[64:79]
    ds_read_b64_tr_b16 v[20:21], v10 offset:24576
    ds_read_b64_tr_b16 v[22:23], v10 offset:25088
    v_mfma_f32_32x32x16_bf16 v[80:95], v[28:31], v[228:231], v[80:95]
    ds_read_b64_tr_b16 v[24:25], v9 offset:26624
    ds_read_b64_tr_b16 v[26:27], v9 offset:27136
    s_waitcnt lgkmcnt(14)
    v_mfma_f32_32x32x16_bf16 v[64:79], v[32:35], v[232:235], v[64:79]
    ds_read_b64_tr_b16 v[28:29], v10 offset:26624
    ds_read_b64_tr_b16 v[30:31], v10 offset:27136
    v_mfma_f32_32x32x16_bf16 v[80:95], v[36:39], v[232:235], v[80:95]
    ds_read_b64_tr_b16 v[32:33], v9 offset:28672
    ds_read_b64_tr_b16 v[34:35], v9 offset:29184
    s_waitcnt lgkmcnt(14)
    v_mfma_f32_32x32x16_bf16 v[64:79], v[40:43], v[236:239], v[64:79]
    ds_read_b64_tr_b16 v[36:37], v10 offset:28672
    ds_read_b64_tr_b16 v[38:39], v10 offset:29184
    v_mfma_f32_32x32x16_bf16 v[80:95], v[44:47], v[236:239], v[80:95]
    ds_read_b64_tr_b16 v[40:41], v9 offset:30720
    ds_read_b64_tr_b16 v[42:43], v9 offset:31232
    s_waitcnt lgkmcnt(14)
    s_waitcnt vmcnt(2)
    s_barrier
    s_waitcnt lgkmcnt(10)
    v_mfma_f32_32x32x16_bf16 v[64:79], v[16:19], v[240:243], v[64:79]
    ds_read_b64_tr_b16 v[44:45], v10 offset:30720
    ds_read_b64_tr_b16 v[46:47], v10 offset:31232
    s_add_u32 s38, s35, 2
    s_and_b32 s38, s38, 7
    s_mul_i32 s38, s38, 229376
    s_add_u32 s70, s37, s38
    s_add_u32 m0, s68, 65536
    s_add_u32 s70, s70, 128
    buffer_load_dwordx4 v4, s[12:15], s70 offen  lds
    v_mfma_f32_32x32x16_bf16 v[80:95], v[20:23], v[240:243], v[80:95]
    ds_read_b64_tr_b16 v[16:17], v9 offset:0
    ds_read_b64_tr_b16 v[18:19], v9 offset:512
    s_add_u32 m0, s68, 65536
    s_add_u32 s70, s70, 27648
    buffer_load_dwordx4 v4, s[12:15], s70 offen offset:1024  lds
    s_waitcnt lgkmcnt(10)
    v_mfma_f32_32x32x16_bf16 v[64:79], v[24:27], v[244:247], v[64:79]
    ds_read_b64_tr_b16 v[20:21], v10 offset:0
    ds_read_b64_tr_b16 v[22:23], v10 offset:512
    v_mfma_f32_32x32x16_bf16 v[80:95], v[28:31], v[244:247], v[80:95]
    ds_read_b64_tr_b16 v[24:25], v9 offset:2048
    ds_read_b64_tr_b16 v[26:27], v9 offset:2560
    s_waitcnt lgkmcnt(10)
    v_mfma_f32_32x32x16_bf16 v[64:79], v[32:35], v[248:251], v[64:79]
    ds_read_b64_tr_b16 v[28:29], v10 offset:2048
    ds_read_b64_tr_b16 v[30:31], v10 offset:2560
    v_mfma_f32_32x32x16_bf16 v[80:95], v[36:39], v[248:251], v[80:95]
    ds_read_b64_tr_b16 v[32:33], v9 offset:4096
    ds_read_b64_tr_b16 v[34:35], v9 offset:4608
    s_waitcnt lgkmcnt(10)
    v_mfma_f32_32x32x16_bf16 v[64:79], v[40:43], v[252:255], v[64:79]
    ds_read_b64_tr_b16 v[36:37], v10 offset:4096
    ds_read_b64_tr_b16 v[38:39], v10 offset:4608
    v_mfma_f32_32x32x16_bf16 v[80:95], v[44:47], v[252:255], v[80:95]
    ds_read_b64_tr_b16 v[40:41], v9 offset:6144
    ds_read_b64_tr_b16 v[42:43], v9 offset:6656
    s_waitcnt vmcnt(2)
    s_barrier
    s_mov_b32 s66, 0x42700000
    s_nop 3
    v_pk_mul_f32 v[48:49], v[64:65], s[44:45]
    v_pk_mul_f32 v[50:51], v[66:67], s[44:45]
    v_pk_mul_f32 v[52:53], v[68:69], s[44:45]
    v_pk_mul_f32 v[54:55], v[70:71], s[44:45]
    s_add_u32 s38, s35, 3
    s_and_b32 s38, s38, 7
    s_mul_i32 s38, s38, 229376
    s_add_u32 s70, s37, s38
    s_add_u32 m0, s68, 73728
    s_add_u32 s70, s70, 128
    buffer_load_dwordx4 v4, s[12:15], s70 offen  lds
    v_min_f32 v48, s66, v48
    v_min_f32 v50, s66, v50
    v_min_f32 v52, s66, v52
    v_min_f32 v54, s66, v54
    v_min_f32 v49, s66, v49
    v_min_f32 v51, s66, v51
    v_min_f32 v53, s66, v53
    v_min_f32 v55, s66, v55
    v_exp_f32 v48, v48
    v_exp_f32 v50, v50
    v_exp_f32 v52, v52
    v_exp_f32 v54, v54
    v_exp_f32 v49, v49
    v_exp_f32 v51, v51
    v_exp_f32 v53, v53
    v_exp_f32 v55, v55
    v_pk_add_f32 v[56:57], v[48:49], 2.0 op_sel_hi:[1,0]
    v_pk_add_f32 v[58:59], v[50:51], 2.0 op_sel_hi:[1,0]
    v_pk_add_f32 v[60:61], v[52:53], 2.0 op_sel_hi:[1,0]
    v_pk_add_f32 v[62:63], v[54:55], 2.0 op_sel_hi:[1,0]
    s_add_u32 m0, s68, 73728
    s_add_u32 s70, s70, 27648
    buffer_load_dwordx4 v4, s[12:15], s70 offen offset:1024  lds
    v_pk_mul_f32 v[56:57], v[48:49], v[56:57]
    v_pk_mul_f32 v[58:59], v[50:51], v[58:59]
    v_pk_mul_f32 v[60:61], v[52:53], v[60:61]
    v_pk_mul_f32 v[62:63], v[54:55], v[62:63]
    v_pk_add_f32 v[48:49], v[56:57], 2.0 op_sel_hi:[1,0]
    v_pk_add_f32 v[50:51], v[58:59], 2.0 op_sel_hi:[1,0]
    v_pk_add_f32 v[52:53], v[60:61], 2.0 op_sel_hi:[1,0]
    v_pk_add_f32 v[54:55], v[62:63], 2.0 op_sel_hi:[1,0]
    v_rcp_f32 v48, v48
    v_rcp_f32 v50, v50
    v_rcp_f32 v52, v52
    v_rcp_f32 v54, v54
    v_rcp_f32 v49, v49
    v_rcp_f32 v51, v51
    v_rcp_f32 v53, v53
    v_rcp_f32 v55, v55
    v_pk_mul_f32 v[48:49], v[56:57], v[48:49]
    v_pk_mul_f32 v[50:51], v[58:59], v[50:51]
    v_pk_mul_f32 v[52:53], v[60:61], v[52:53]
    v_pk_mul_f32 v[54:55], v[62:63], v[54:55]
    s_add_u32 s38, s35, 4
    s_and_b32 s38, s38, 7
    s_mul_i32 s38, s38, 229376
    s_add_u32 s70, s37, s38
    s_add_u32 m0, s68, 16384
    s_add_u32 s70, s70, 128
    buffer_load_dwordx4 v4, s[12:15], s70 offen  lds
    v_pk_mul_f32 v[48:49], v[64:65], v[48:49]
    v_pk_mul_f32 v[50:51], v[66:67], v[50:51]
    v_pk_mul_f32 v[52:53], v[68:69], v[52:53]
    v_pk_mul_f32 v[54:55], v[70:71], v[54:55]
    v_cvt_pk_bf16_f32 v56, v48, v49
    v_cvt_pk_bf16_f32 v57, v50, v51
    v_cvt_pk_bf16_f32 v58, v52, v53
    v_cvt_pk_bf16_f32 v59, v54, v55
    v_xor_b32 v60, 0, v11
    v_xor_b32 v61, 16, v11
    ds_write_b64 v60, v[56:57] offset:0
    ds_write_b64 v61, v[58:59] offset:0
    v_pk_mul_f32 v[48:49], v[72:73], s[44:45]
    v_pk_mul_f32 v[50:51], v[74:75], s[44:45]
    v_pk_mul_f32 v[52:53], v[76:77], s[44:45]
    v_pk_mul_f32 v[54:55], v[78:79], s[44:45]
    v_min_f32 v48, s66, v48
    v_min_f32 v50, s66, v50
    v_min_f32 v52, s66, v52
    v_min_f32 v54, s66, v54
    s_add_u32 m0, s68, 16384
    s_add_u32 s70, s70, 27648
    buffer_load_dwordx4 v4, s[12:15], s70 offen offset:1024  lds
    v_min_f32 v49, s66, v49
    v_min_f32 v51, s66, v51
    v_min_f32 v53, s66, v53
    v_min_f32 v55, s66, v55
    v_exp_f32 v48, v48
    v_exp_f32 v50, v50
    v_exp_f32 v52, v52
    v_exp_f32 v54, v54
    v_exp_f32 v49, v49
    v_exp_f32 v51, v51
    v_exp_f32 v53, v53
    v_exp_f32 v55, v55
    v_pk_add_f32 v[56:57], v[48:49], 2.0 op_sel_hi:[1,0]
    v_pk_add_f32 v[58:59], v[50:51], 2.0 op_sel_hi:[1,0]
    v_pk_add_f32 v[60:61], v[52:53], 2.0 op_sel_hi:[1,0]
    v_pk_add_f32 v[62:63], v[54:55], 2.0 op_sel_hi:[1,0]
    v_pk_mul_f32 v[56:57], v[48:49], v[56:57]
    v_pk_mul_f32 v[58:59], v[50:51], v[58:59]
    v_pk_mul_f32 v[60:61], v[52:53], v[60:61]
    v_pk_mul_f32 v[62:63], v[54:55], v[62:63]
    s_add_u32 s38, s35, 5
    s_and_b32 s38, s38, 7
    s_mul_i32 s38, s38, 229376
    s_add_u32 s70, s37, s38
    s_add_u32 m0, s68, 24576
    s_add_u32 s70, s70, 128
    buffer_load_dwordx4 v4, s[12:15], s70 offen  lds
    v_pk_add_f32 v[48:49], v[56:57], 2.0 op_sel_hi:[1,0]
    v_pk_add_f32 v[50:51], v[58:59], 2.0 op_sel_hi:[1,0]
    v_pk_add_f32 v[52:53], v[60:61], 2.0 op_sel_hi:[1,0]
    v_pk_add_f32 v[54:55], v[62:63], 2.0 op_sel_hi:[1,0]
    v_rcp_f32 v48, v48
    v_rcp_f32 v50, v50
    v_rcp_f32 v52, v52
    v_rcp_f32 v54, v54
    v_rcp_f32 v49, v49
    v_rcp_f32 v51, v51
    v_rcp_f32 v53, v53
    v_rcp_f32 v55, v55
    v_pk_mul_f32 v[48:49], v[56:57], v[48:49]
    v_pk_mul_f32 v[50:51], v[58:59], v[50:51]
    v_pk_mul_f32 v[52:53], v[60:61], v[52:53]
    v_pk_mul_f32 v[54:55], v[62:63], v[54:55]
    v_pk_mul_f32 v[48:49], v[72:73], v[48:49]
    v_pk_mul_f32 v[50:51], v[74:75], v[50:51]
    v_pk_mul_f32 v[52:53], v[76:77], v[52:53]
    v_pk_mul_f32 v[54:55], v[78:79], v[54:55]
    s_add_u32 m0, s68, 24576
    s_add_u32 s70, s70, 27648
    buffer_load_dwordx4 v4, s[12:15], s70 offen offset:1024  lds
    v_cvt_pk_bf16_f32 v56, v48, v49
    v_cvt_pk_bf16_f32 v57, v50, v51
    v_cvt_pk_bf16_f32 v58, v52, v53
    v_cvt_pk_bf16_f32 v59, v54, v55
    v_xor_b32 v60, 32, v11
    v_xor_b32 v61, 48, v11
    ds_write_b64 v60, v[56:57] offset:0
    ds_write_b64 v61, v[58:59] offset:0
    v_pk_mul_f32 v[48:49], v[80:81], s[44:45]
    v_pk_mul_f32 v[50:51], v[82:83], s[44:45]
    v_pk_mul_f32 v[52:53], v[84:85], s[44:45]
    v_pk_mul_f32 v[54:55], v[86:87], s[44:45]
    v_min_f32 v48, s66, v48
    v_min_f32 v50, s66, v50
    v_min_f32 v52, s66, v52
    v_min_f32 v54, s66, v54
    v_min_f32 v49, s66, v49
    v_min_f32 v51, s66, v51
    v_min_f32 v53, s66, v53
    v_min_f32 v55, s66, v55
    s_add_u32 s38, s35, 6
    s_and_b32 s38, s38, 7
    s_mul_i32 s38, s38, 229376
    s_add_u32 s70, s37, s38
    s_add_u32 m0, s68, 32768
    s_add_u32 s70, s70, 128
    buffer_load_dwordx4 v4, s[12:15], s70 offen  lds
    v_exp_f32 v48, v48
    v_exp_f32 v50, v50
    v_exp_f32 v52, v52
    v_exp_f32 v54, v54
    v_exp_f32 v49, v49
    v_exp_f32 v51, v51
    v_exp_f32 v53, v53
    v_exp_f32 v55, v55
    v_pk_add_f32 v[56:57], v[48:49], 2.0 op_sel_hi:[1,0]
    v_pk_add_f32 v[58:59], v[50:51], 2.0 op_sel_hi:[1,0]
    v_pk_add_f32 v[60:61], v[52:53], 2.0 op_sel_hi:[1,0]
    v_pk_add_f32 v[62:63], v[54:55], 2.0 op_sel_hi:[1,0]
    v_pk_mul_f32 v[56:57], v[48:49], v[56:57]
    v_pk_mul_f32 v[58:59], v[50:51], v[58:59]
    v_pk_mul_f32 v[60:61], v[52:53], v[60:61]
    v_pk_mul_f32 v[62:63], v[54:55], v[62:63]
    v_pk_add_f32 v[48:49], v[56:57], 2.0 op_sel_hi:[1,0]
    v_pk_add_f32 v[50:51], v[58:59], 2.0 op_sel_hi:[1,0]
    v_pk_add_f32 v[52:53], v[60:61], 2.0 op_sel_hi:[1,0]
    v_pk_add_f32 v[54:55], v[62:63], 2.0 op_sel_hi:[1,0]
    s_add_u32 m0, s68, 32768
    s_add_u32 s70, s70, 27648
    buffer_load_dwordx4 v4, s[12:15], s70 offen offset:1024  lds
    v_rcp_f32 v48, v48
    v_rcp_f32 v50, v50
    v_rcp_f32 v52, v52
    v_rcp_f32 v54, v54
    v_rcp_f32 v49, v49
    v_rcp_f32 v51, v51
    v_rcp_f32 v53, v53
    v_rcp_f32 v55, v55
    v_pk_mul_f32 v[48:49], v[56:57], v[48:49]
    v_pk_mul_f32 v[50:51], v[58:59], v[50:51]
    v_pk_mul_f32 v[52:53], v[60:61], v[52:53]
    v_pk_mul_f32 v[54:55], v[62:63], v[54:55]
    v_pk_mul_f32 v[48:49], v[80:81], v[48:49]
    v_pk_mul_f32 v[50:51], v[82:83], v[50:51]
    v_pk_mul_f32 v[52:53], v[84:85], v[52:53]
    v_pk_mul_f32 v[54:55], v[86:87], v[54:55]
    v_cvt_pk_bf16_f32 v56, v48, v49
    v_cvt_pk_bf16_f32 v57, v50, v51
    v_cvt_pk_bf16_f32 v58, v52, v53
    v_cvt_pk_bf16_f32 v59, v54, v55
    s_add_u32 s38, s35, 7
    s_and_b32 s38, s38, 7
    s_mul_i32 s38, s38, 229376
    s_add_u32 s70, s37, s38
    s_add_u32 m0, s68, 40960
    s_add_u32 s70, s70, 128
    buffer_load_dwordx4 v4, s[12:15], s70 offen  lds
    v_xor_b32 v60, 64, v11
    v_xor_b32 v61, 80, v11
    ds_write_b64 v60, v[56:57] offset:0
    ds_write_b64 v61, v[58:59] offset:0
    v_pk_mul_f32 v[48:49], v[88:89], s[44:45]
    v_pk_mul_f32 v[50:51], v[90:91], s[44:45]
    v_pk_mul_f32 v[52:53], v[92:93], s[44:45]
    v_pk_mul_f32 v[54:55], v[94:95], s[44:45]
    v_min_f32 v48, s66, v48
    v_min_f32 v50, s66, v50
    v_min_f32 v52, s66, v52
    v_min_f32 v54, s66, v54
    v_min_f32 v49, s66, v49
    v_min_f32 v51, s66, v51
    v_min_f32 v53, s66, v53
    v_min_f32 v55, s66, v55
    v_exp_f32 v48, v48
    v_exp_f32 v50, v50
    v_exp_f32 v52, v52
    v_exp_f32 v54, v54
    s_add_u32 m0, s68, 40960
    s_add_u32 s70, s70, 27648
    buffer_load_dwordx4 v4, s[12:15], s70 offen offset:1024  lds
    v_exp_f32 v49, v49
    v_exp_f32 v51, v51
    v_exp_f32 v53, v53
    v_exp_f32 v55, v55
    v_pk_add_f32 v[56:57], v[48:49], 2.0 op_sel_hi:[1,0]
    v_pk_add_f32 v[58:59], v[50:51], 2.0 op_sel_hi:[1,0]
    v_pk_add_f32 v[60:61], v[52:53], 2.0 op_sel_hi:[1,0]
    v_pk_add_f32 v[62:63], v[54:55], 2.0 op_sel_hi:[1,0]
    v_pk_mul_f32 v[56:57], v[48:49], v[56:57]
    v_pk_mul_f32 v[58:59], v[50:51], v[58:59]
    v_pk_mul_f32 v[60:61], v[52:53], v[60:61]
    v_pk_mul_f32 v[62:63], v[54:55], v[62:63]
    v_pk_add_f32 v[48:49], v[56:57], 2.0 op_sel_hi:[1,0]
    v_pk_add_f32 v[50:51], v[58:59], 2.0 op_sel_hi:[1,0]
    v_pk_add_f32 v[52:53], v[60:61], 2.0 op_sel_hi:[1,0]
    v_pk_add_f32 v[54:55], v[62:63], 2.0 op_sel_hi:[1,0]
    v_rcp_f32 v48, v48
    v_rcp_f32 v50, v50
    v_rcp_f32 v52, v52
    v_rcp_f32 v54, v54
    v_rcp_f32 v49, v49
    v_rcp_f32 v51, v51
    v_rcp_f32 v53, v53
    v_rcp_f32 v55, v55
    v_pk_mul_f32 v[48:49], v[56:57], v[48:49]
    v_pk_mul_f32 v[50:51], v[58:59], v[50:51]
    v_pk_mul_f32 v[52:53], v[60:61], v[52:53]
    v_pk_mul_f32 v[54:55], v[62:63], v[54:55]
    v_pk_mul_f32 v[48:49], v[88:89], v[48:49]
    v_pk_mul_f32 v[50:51], v[90:91], v[50:51]
    v_pk_mul_f32 v[52:53], v[92:93], v[52:53]
    v_pk_mul_f32 v[54:55], v[94:95], v[54:55]
    v_cvt_pk_bf16_f32 v56, v48, v49
    v_cvt_pk_bf16_f32 v57, v50, v51
    v_cvt_pk_bf16_f32 v58, v52, v53
    v_cvt_pk_bf16_f32 v59, v54, v55
    v_xor_b32 v60, 96, v11
    v_xor_b32 v61, 112, v11
    ds_write_b64 v60, v[56:57] offset:0
    ds_write_b64 v61, v[58:59] offset:0
    s_lshr_b32 s38, s6, 1
    s_lshl_b32 s39, s33, 1
    s_add_u32 s38, s38, s39
    s_mul_i32 s38, s38, 229376
    s_lshl_b32 s39, s34, 14
    s_add_u32 s38, s38, s39
    s_and_b32 s39, s6, 1
    s_lshl_b32 s39, s39, 12
    s_add_u32 s38, s38, s39
    s_add_u32 s71, s38, 13631488
    s_mov_b32 s74, s71
    s_waitcnt lgkmcnt(0)
    ds_read_b128 v[48:51], v12 offset:0
    ds_read_b128 v[52:55], v12 offset:1024
    ds_read_b128 v[56:59], v12 offset:2048
    ds_read_b128 v[60:63], v12 offset:3072
    v_mfma_f32_32x32x16_bf16 v[96:111], v[16:19], v[128:131], v[96:111]
    ds_read_b64_tr_b16 v[44:45], v10 offset:6144
    ds_read_b64_tr_b16 v[46:47], v10 offset:6656
    s_waitcnt lgkmcnt(5)
    buffer_store_dwordx4 v[48:51], v13, s[24:27], s71 offen offset:0 sc1
    v_mfma_f32_32x32x16_bf16 v[112:127], v[20:23], v[128:131], v[112:127]
    ds_read_b64_tr_b16 v[16:17], v9 offset:8192
    ds_read_b64_tr_b16 v[18:19], v9 offset:8704
    s_waitcnt lgkmcnt(6)
    buffer_store_dwordx4 v[52:55], v13, s[24:27], s71 offen offset:1024 sc1
    v_mfma_f32_32x32x16_bf16 v[96:111], v[24:27], v[132:135], v[96:111]
    ds_read_b64_tr_b16 v[20:21], v10 offset:8192
    ds_read_b64_tr_b16 v[22:23], v10 offset:8704
    s_waitcnt lgkmcnt(7)
    buffer_store_dwordx4 v[56:59], v13, s[24:27], s71 offen offset:2048 sc1
    v_mfma_f32_32x32x16_bf16 v[112:127], v[28:31], v[132:135], v[112:127]
    ds_read_b64_tr_b16 v[24:25], v9 offset:10240
    ds_read_b64_tr_b16 v[26:27], v9 offset:10752
    s_waitcnt lgkmcnt(8)
    buffer_store_dwordx4 v[60:63], v13, s[24:27], s71 offen offset:3072 sc1
    v_mfma_f32_32x32x16_bf16 v[96:111], v[32:35], v[136:139], v[96:111]
    ds_read_b64_tr_b16 v[28:29], v10 offset:10240
    ds_read_b64_tr_b16 v[30:31], v10 offset:10752
    v_mfma_f32_32x32x16_bf16 v[112:127], v[36:39], v[136:139], v[112:127]
    ds_read_b64_tr_b16 v[32:33], v9 offset:12288
    ds_read_b64_tr_b16 v[34:35], v9 offset:12800
    s_waitcnt lgkmcnt(10)
    v_mfma_f32_32x32x16_bf16 v[96:111], v[40:43], v[140:143], v[96:111]
    ds_read_b64_tr_b16 v[36:37], v10 offset:12288
    ds_read_b64_tr_b16 v[38:39], v10 offset:12800
    v_subrev_u32 v62, 49152, v9
    v_subrev_u32 v63, 49152, v10
    v_mfma_f32_32x32x16_bf16 v[112:127], v[44:47], v[140:143], v[112:127]
    ds_read_b64_tr_b16 v[40:41], v9 offset:14336
    ds_read_b64_tr_b16 v[42:43], v9 offset:14848
    s_waitcnt vmcnt(14)
    s_barrier
    s_waitcnt lgkmcnt(10)
    v_mfma_f32_32x32x16_bf16 v[96:111], v[16:19], v[144:147], v[96:111]
    ds_read_b64_tr_b16 v[44:45], v10 offset:14336
    ds_read_b64_tr_b16 v[46:47], v10 offset:14848
    v_mfma_f32_32x32x16_bf16 v[112:127], v[20:23], v[144:147], v[112:127]
    ds_read_b64_tr_b16 v[16:17], v9 offset:16384
    ds_read_b64_tr_b16 v[18:19], v9 offset:16896
    s_waitcnt lgkmcnt(10)
    v_mfma_f32_32x32x16_bf16 v[96:111], v[24:27], v[148:151], v[96:111]
    ds_read_b64_tr_b16 v[20:21], v10 offset:16384
    ds_read_b64_tr_b16 v[22:23], v10 offset:16896
    v_mfma_f32_32x32x16_bf16 v[112:127], v[28:31], v[148:151], v[112:127]
    ds_read_b64_tr_b16 v[24:25], v9 offset:18432
    ds_read_b64_tr_b16 v[26:27], v9 offset:18944
    s_waitcnt lgkmcnt(10)
    v_mfma_f32_32x32x16_bf16 v[96:111], v[32:35], v[152:155], v[96:111]
    ds_read_b64_tr_b16 v[28:29], v10 offset:18432
    ds_read_b64_tr_b16 v[30:31], v10 offset:18944
    v_mfma_f32_32x32x16_bf16 v[112:127], v[36:39], v[152:155], v[112:127]
    ds_read_b64_tr_b16 v[32:33], v9 offset:20480
    ds_read_b64_tr_b16 v[34:35], v9 offset:20992
    s_waitcnt lgkmcnt(10)
    v_mfma_f32_32x32x16_bf16 v[96:111], v[40:43], v[156:159], v[96:111]
    ds_read_b64_tr_b16 v[36:37], v10 offset:20480
    ds_read_b64_tr_b16 v[38:39], v10 offset:20992
    v_mfma_f32_32x32x16_bf16 v[112:127], v[44:47], v[156:159], v[112:127]
    ds_read_b64_tr_b16 v[40:41], v9 offset:22528
    ds_read_b64_tr_b16 v[42:43], v9 offset:23040
    s_waitcnt vmcnt(12)
    s_barrier
    s_waitcnt lgkmcnt(10)
    v_mfma_f32_32x32x16_bf16 v[96:111], v[16:19], v[160:163], v[96:111]
    ds_read_b64_tr_b16 v[44:45], v10 offset:22528
    ds_read_b64_tr_b16 v[46:47], v10 offset:23040
    v_mfma_f32_32x32x16_bf16 v[112:127], v[20:23], v[160:163], v[112:127]
    ds_read_b64_tr_b16 v[16:17], v9 offset:24576
    ds_read_b64_tr_b16 v[18:19], v9 offset:25088
    s_waitcnt lgkmcnt(10)
    v_mfma_f32_32x32x16_bf16 v[96:111], v[24:27], v[164:167], v[96:111]
    ds_read_b64_tr_b16 v[20:21], v10 offset:24576
    ds_read_b64_tr_b16 v[22:23], v10 offset:25088
    v_mfma_f32_32x32x16_bf16 v[112:127], v[28:31], v[164:167], v[112:127]
    ds_read_b64_tr_b16 v[24:25], v9 offset:26624
    ds_read_b64_tr_b16 v[26:27], v9 offset:27136
    s_waitcnt lgkmcnt(10)
    v_mfma_f32_32x32x16_bf16 v[96:111], v[32:35], v[168:171], v[96:111]
    ds_read_b64_tr_b16 v[28:29], v10 offset:26624
    ds_read_b64_tr_b16 v[30:31], v10 offset:27136
    v_mfma_f32_32x32x16_bf16 v[112:127], v[36:39], v[168:171], v[112:127]
    ds_read_b64_tr_b16 v[32:33], v9 offset:28672
    ds_read_b64_tr_b16 v[34:35], v9 offset:29184
    s_waitcnt lgkmcnt(10)
    v_mfma_f32_32x32x16_bf16 v[96:111], v[40:43], v[172:175], v[96:111]
    ds_read_b64_tr_b16 v[36:37], v10 offset:28672
    ds_read_b64_tr_b16 v[38:39], v10 offset:29184
    v_mfma_f32_32x32x16_bf16 v[112:127], v[44:47], v[172:175], v[112:127]
    ds_read_b64_tr_b16 v[40:41], v9 offset:30720
    ds_read_b64_tr_b16 v[42:43], v9 offset:31232
    s_waitcnt vmcnt(10)
    s_barrier
    s_waitcnt lgkmcnt(10)
    v_mfma_f32_32x32x16_bf16 v[96:111], v[16:19], v[176:179], v[96:111]
    ds_read_b64_tr_b16 v[44:45], v10 offset:30720
    ds_read_b64_tr_b16 v[46:47], v10 offset:31232
    v_mfma_f32_32x32x16_bf16 v[112:127], v[20:23], v[176:179], v[112:127]
    ds_read_b64_tr_b16 v[16:17], v62 offset:16384
    ds_read_b64_tr_b16 v[18:19], v62 offset:16896
    s_waitcnt lgkmcnt(10)
    v_mfma_f32_32x32x16_bf16 v[96:111], v[24:27], v[180:183], v[96:111]
    ds_read_b64_tr_b16 v[20:21], v63 offset:16384
    ds_read_b64_tr_b16 v[22:23], v63 offset:16896
    v_mfma_f32_32x32x16_bf16 v[112:127], v[28:31], v[180:183], v[112:127]
    ds_read_b64_tr_b16 v[24:25], v62 offset:18432
    ds_read_b64_tr_b16 v[26:27], v62 offset:18944
    s_waitcnt lgkmcnt(10)
    v_mfma_f32_32x32x16_bf16 v[96:111], v[32:35], v[184:187], v[96:111]
    ds_read_b64_tr_b16 v[28:29], v63 offset:18432
    ds_read_b64_tr_b16 v[30:31], v63 offset:18944
    v_mfma_f32_32x32x16_bf16 v[112:127], v[36:39], v[184:187], v[112:127]
    ds_read_b64_tr_b16 v[32:33], v62 offset:20480
    ds_read_b64_tr_b16 v[34:35], v62 offset:20992
    s_waitcnt lgkmcnt(10)
    v_mfma_f32_32x32x16_bf16 v[96:111], v[40:43], v[188:191], v[96:111]
    ds_read_b64_tr_b16 v[36:37], v63 offset:20480
    ds_read_b64_tr_b16 v[38:39], v63 offset:20992
    v_mfma_f32_32x32x16_bf16 v[112:127], v[44:47], v[188:191], v[112:127]
    ds_read_b64_tr_b16 v[40:41], v62 offset:22528
    ds_read_b64_tr_b16 v[42:43], v62 offset:23040
    s_waitcnt vmcnt(0)
    s_barrier
    s_waitcnt lgkmcnt(0)
    s_add_u32 s32, s32, 1
    s_cmp_eq_u32 s6, 0
    s_cselect_b32 s41, 0, 0x7ff00000
    s_lshl_b32 s40, s73, 7
    s_add_u32 s40, s40, 65536
    v_mov_b32 v14, s32
    v_mov_b32 v15, s41
    s_mov_b64 s[46:47], exec
    s_mov_b64 exec, 1
    buffer_store_dword v14, v15, s[24:27], s40 offen sc0 sc1
    s_mov_b64 exec, s[46:47]
    s_waitcnt lgkmcnt(10)
    v_mfma_f32_32x32x16_bf16 v[96:111], v[16:19], v[192:195], v[96:111]
    ds_read_b64_tr_b16 v[44:45], v63 offset:22528
    ds_read_b64_tr_b16 v[46:47], v63 offset:23040
    s_lshl_b32 s48, s4, 2
    s_and_b32 s38, s5, 3
    s_add_u32 s48, s48, s38
    s_lshr_b32 s49, s5, 2
    v_mfma_f32_32x32x16_bf16 v[112:127], v[20:23], v[192:195], v[112:127]
    ds_read_b64_tr_b16 v[16:17], v62 offset:24576
    ds_read_b64_tr_b16 v[18:19], v62 offset:25088
    s_mul_i32 s39, s49, 7
    s_lshr_b32 s39, s39, 2
    s_mul_i32 s38, s38, 3
    s_add_u32 s50, s39, s38
    s_waitcnt lgkmcnt(10)
    v_mfma_f32_32x32x16_bf16 v[96:111], v[24:27], v[196:199], v[96:111]
    ds_read_b64_tr_b16 v[20:21], v63 offset:24576
    ds_read_b64_tr_b16 v[22:23], v63 offset:25088
    s_cmp_ge_u32 s50, 14
    s_cselect_b32 s38, 14, 0
    s_sub_u32 s50, s50, s38
    s_cmp_ge_u32 s50, 14
    v_mfma_f32_32x32x16_bf16 v[112:127], v[28:31], v[196:199], v[112:127]
    ds_read_b64_tr_b16 v[24:25], v62 offset:26624
    ds_read_b64_tr_b16 v[26:27], v62 offset:27136
    s_cselect_b32 s38, 14, 0
    s_sub_u32 s50, s50, s38
    s_mov_b32 s51, 0
    s_mov_b32 s52, 0
    s_waitcnt lgkmcnt(10)
    v_mfma_f32_32x32x16_bf16 v[96:111], v[32:35], v[200:203], v[96:111]
    ds_read_b64_tr_b16 v[28:29], v63 offset:26624
    ds_read_b64_tr_b16 v[30:31], v63 offset:27136
    s_mul_i32 s53, s48, 229376
    s_lshl_b32 s38, s6, 11
    s_add_u32 s53, s53, s38
    s_add_u32 s53, s53, 13631488
    v_mfma_f32_32x32x16_bf16 v[112:127], v[36:39], v[200:203], v[112:127]
    ds_read_b64_tr_b16 v[32:33], v62 offset:28672
    ds_read_b64_tr_b16 v[34:35], v62 offset:29184
    s_lshl_b32 s54, s6, 14
    s_lshl_b32 s38, s49, 7
    s_add_u32 s54, s54, s38
    s_lshl_b32 s68, s6, 11
    s_waitcnt lgkmcnt(10)
    v_mfma_f32_32x32x16_bf16 v[96:111], v[40:43], v[204:207], v[96:111]
    ds_read_b64_tr_b16 v[36:37], v63 offset:28672
    ds_read_b64_tr_b16 v[38:39], v63 offset:29184
    v_lshrrev_b32 v65, 4, v1
    v_and_b32 v66, 7, v1
    v_xor_b32 v64, v66, v65
    v_lshlrev_b32 v64, 4, v64
    v_mfma_f32_32x32x16_bf16 v[112:127], v[44:47], v[204:207], v[112:127]
    ds_read_b64_tr_b16 v[40:41], v62 offset:30720
    ds_read_b64_tr_b16 v[42:43], v62 offset:31232
    v_lshrrev_b32 v67, 3, v1
    v_lshl_add_u32 v2, v67, 7, v64
    v_add_u32 v65, 4, v65
    v_xor_b32 v64, v66, v65
    s_barrier
    s_waitcnt lgkmcnt(10)
    v_mfma_f32_32x32x16_bf16 v[96:111], v[16:19], v[208:211], v[96:111]
    ds_read_b64_tr_b16 v[44:45], v63 offset:30720
    ds_read_b64_tr_b16 v[46:47], v63 offset:31232
    v_lshlrev_b32 v64, 4, v64
    v_lshl_add_u32 v3, v67, 7, v64
    v_bfe_u32 v65, v1, 4, 1
    v_lshlrev_b32 v65, 2, v65
    v_mfma_f32_32x32x16_bf16 v[112:127], v[20:23], v[208:211], v[112:127]
    ds_read_b64_tr_b16 v[16:17], v62 offset:32768
    ds_read_b64_tr_b16 v[18:19], v62 offset:33280
    v_and_b32 v66, 7, v1
    v_xor_b32 v66, v66, v65
    v_lshlrev_b32 v66, 4, v66
    v_lshrrev_b32 v67, 3, v1
    s_waitcnt lgkmcnt(10)
    v_mfma_f32_32x32x16_bf16 v[96:111], v[24:27], v[212:215], v[96:111]
    ds_read_b64_tr_b16 v[20:21], v63 offset:32768
    ds_read_b64_tr_b16 v[22:23], v63 offset:33280
    v_mul_u32_u24 v67, 1024, v67
    v_add_u32 v4, v66, v67
    s_lshr_b32 s38, s6, 1
    s_lshl_b32 s38, s38, 12
    v_mfma_f32_32x32x16_bf16 v[112:127], v[28:31], v[212:215], v[112:127]
    ds_read_b64_tr_b16 v[24:25], v62 offset:34816
    ds_read_b64_tr_b16 v[26:27], v62 offset:35328
    v_and_b32 v64, 31, v1
    v_lshrrev_b32 v65, 5, v1
    v_bfe_u32 v66, v64, 1, 3
    v_lshlrev_b32 v64, 7, v64
    s_waitcnt lgkmcnt(10)
    v_mfma_f32_32x32x16_bf16 v[96:111], v[32:35], v[216:219], v[96:111]
    ds_read_b64_tr_b16 v[28:29], v63 offset:34816
    ds_read_b64_tr_b16 v[30:31], v63 offset:35328
    v_add_u32 v64, s38, v64
    v_add_u32 v67, 0, v65
    v_xor_b32 v67, v67, v66
    v_lshl_add_u32 v5, v67, 4, v64
    v_mfma_f32_32x32x16_bf16 v[112:127], v[36:39], v[216:219], v[112:127]
    ds_read_b64_tr_b16 v[32:33], v62 offset:36864
    ds_read_b64_tr_b16 v[34:35], v62 offset:37376
    v_add_u32 v67, 2, v65
    v_xor_b32 v67, v67, v66
    v_lshl_add_u32 v6, v67, 4, v64
    v_add_u32 v67, 4, v65
    s_waitcnt lgkmcnt(10)
    v_mfma_f32_32x32x16_bf16 v[96:111], v[40:43], v[220:223], v[96:111]
    ds_read_b64_tr_b16 v[36:37], v63 offset:36864
    ds_read_b64_tr_b16 v[38:39], v63 offset:37376
    v_xor_b32 v67, v67, v66
    v_lshl_add_u32 v7, v67, 4, v64
    v_add_u32 v67, 6, v65
    v_xor_b32 v67, v67, v66
    v_mfma_f32_32x32x16_bf16 v[112:127], v[44:47], v[220:223], v[112:127]
    ds_read_b64_tr_b16 v[40:41], v62 offset:38912
    ds_read_b64_tr_b16 v[42:43], v62 offset:39424
    v_lshl_add_u32 v8, v67, 4, v64
    s_and_b32 s39, s6, 1
    v_lshrrev_b32 v64, 5, v1
    v_lshlrev_b32 v64, 3, v64
    s_barrier
    s_waitcnt lgkmcnt(10)
    v_mfma_f32_32x32x16_bf16 v[96:111], v[16:19], v[224:227], v[96:111]
    ds_read_b64_tr_b16 v[44:45], v63 offset:38912
    ds_read_b64_tr_b16 v[46:47], v63 offset:39424
    v_bfe_u32 v65, v1, 2, 2
    v_add_u32 v64, v64, v65
    v_lshlrev_b32 v64, 7, v64
    v_bfe_u32 v65, v1, 3, 1
    v_mfma_f32_32x32x16_bf16 v[112:127], v[20:23], v[224:227], v[112:127]
    ds_read_b64_tr_b16 v[16:17], v62 offset:40960
    ds_read_b64_tr_b16 v[18:19], v62 offset:41472
    v_xor_b32 v65, s39, v65
    v_lshl_add_u32 v64, v65, 6, v64
    v_bfe_u32 v65, v1, 4, 1
    v_lshl_add_u32 v64, v65, 5, v64
    s_waitcnt lgkmcnt(10)
    v_mfma_f32_32x32x16_bf16 v[96:111], v[24:27], v[228:231], v[96:111]
    ds_read_b64_tr_b16 v[20:21], v63 offset:40960
    ds_read_b64_tr_b16 v[22:23], v63 offset:41472
    v_and_b32 v65, 3, v1
    v_lshl_add_u32 v64, v65, 3, v64
    v_add_u32 v9, 32768, v64
    v_mfma_f32_32x32x16_bf16 v[112:127], v[28:31], v[228:231], v[112:127]
    ds_read_b64_tr_b16 v[24:25], v62 offset:43008
    ds_read_b64_tr_b16 v[26:27], v62 offset:43520
    s_waitcnt lgkmcnt(10)
    v_mfma_f32_32x32x16_bf16 v[96:111], v[32:35], v[232:235], v[96:111]
    ds_read_b64_tr_b16 v[28:29], v63 offset:43008
    ds_read_b64_tr_b16 v[30:31], v63 offset:43520
    v_mfma_f32_32x32x16_bf16 v[112:127], v[36:39], v[232:235], v[112:127]
    ds_read_b64_tr_b16 v[32:33], v62 offset:45056
    ds_read_b64_tr_b16 v[34:35], v62 offset:45568
    s_waitcnt lgkmcnt(10)
    v_mfma_f32_32x32x16_bf16 v[96:111], v[40:43], v[236:239], v[96:111]
    ds_read_b64_tr_b16 v[36:37], v63 offset:45056
    ds_read_b64_tr_b16 v[38:39], v63 offset:45568
    v_mfma_f32_32x32x16_bf16 v[112:127], v[44:47], v[236:239], v[112:127]
    ds_read_b64_tr_b16 v[40:41], v62 offset:47104
    ds_read_b64_tr_b16 v[42:43], v62 offset:47616
    s_waitcnt lgkmcnt(10)
    v_mfma_f32_32x32x16_bf16 v[96:111], v[16:19], v[240:243], v[96:111]
    ds_read_b64_tr_b16 v[44:45], v63 offset:47104
    ds_read_b64_tr_b16 v[46:47], v63 offset:47616
    v_mfma_f32_32x32x16_bf16 v[112:127], v[20:23], v[240:243], v[112:127]
    s_waitcnt lgkmcnt(8)
    v_mfma_f32_32x32x16_bf16 v[96:111], v[24:27], v[244:247], v[96:111]
    v_mfma_f32_32x32x16_bf16 v[112:127], v[28:31], v[244:247], v[112:127]
    s_waitcnt lgkmcnt(4)
    v_mfma_f32_32x32x16_bf16 v[96:111], v[32:35], v[248:251], v[96:111]
    v_mfma_f32_32x32x16_bf16 v[112:127], v[36:39], v[248:251], v[112:127]
    s_waitcnt lgkmcnt(0)
    v_mfma_f32_32x32x16_bf16 v[96:111], v[40:43], v[252:255], v[96:111]
    v_mfma_f32_32x32x16_bf16 v[112:127], v[44:47], v[252:255], v[112:127]
K_pre:
    s_waitcnt lgkmcnt(0)
    s_barrier
    s_mov_b32 s41, s50
    s_lshl_b32 s70, s41, 17
    s_add_u32 s70, s70, s54
    s_add_u32 m0, s68, 32768
    s_add_u32 s41, s41, 1
    buffer_load_dwordx4 v4, s[20:23], s70 offen  lds
    s_add_u32 s70, s70, 7168
    s_cmp_eq_u32 s41, 14
    buffer_load_dwordx4 v4, s[20:23], s70 offen offset:1024  lds
    s_cselect_b32 s41, 0, s41
    s_lshl_b32 s70, s41, 17
    s_add_u32 s70, s70, s54
    s_add_u32 m0, s68, 40960
    s_add_u32 s41, s41, 1
    buffer_load_dwordx4 v4, s[20:23], s70 offen  lds
    s_add_u32 s70, s70, 7168
    s_cmp_eq_u32 s41, 14
    buffer_load_dwordx4 v4, s[20:23], s70 offen offset:1024  lds
    s_cselect_b32 s41, 0, s41
    s_lshl_b32 s70, s41, 17
    s_add_u32 s70, s70, s54
    s_add_u32 m0, s68, 49152
    s_add_u32 s41, s41, 1
    buffer_load_dwordx4 v4, s[20:23], s70 offen  lds
    s_add_u32 s70, s70, 7168
    s_cmp_eq_u32 s41, 14
    buffer_load_dwordx4 v4, s[20:23], s70 offen offset:1024  lds
    s_cselect_b32 s41, 0, s41
    s_lshl_b32 s70, s41, 17
    s_add_u32 s70, s70, s54
    s_add_u32 m0, s68, 57344
    s_add_u32 s41, s41, 1
    buffer_load_dwordx4 v4, s[20:23], s70 offen  lds
    s_add_u32 s70, s70, 7168
    s_cmp_eq_u32 s41, 14
    buffer_load_dwordx4 v4, s[20:23], s70 offen offset:1024  lds
    s_cselect_b32 s41, 0, s41
    s_lshr_b32 s43, s48, 1
    s_lshl_b32 s43, s43, 11
    v_lshlrev_b32 v14, 7, v1
    v_cmp_gt_u32 s[56:57], 14, v1
    v_mov_b32 v15, 0x7ff00000
    s_add_u32 s60, s43, 65536
    v_cndmask_b32_e64 v14, v15, v14, s[56:57]
    buffer_load_dword v15, v14, s[24:27], s60 offen sc0 sc1
    s_cmp_eq_u32 s7, 1
    s_cbranch_scc1 K_dummy
    v_add_u32 v11, 65536, v11
    v_add_u32 v12, 65536, v12
    v_pk_mul_f32 v[48:49], v[96:97], s[44:45]
    v_pk_mul_f32 v[50:51], v[98:99], s[44:45]
    v_pk_mul_f32 v[52:53], v[100:101], s[44:45]
    v_pk_mul_f32 v[54:55], v[102:103], s[44:45]
    v_min_f32 v48, s66, v48
    v_min_f32 v50, s66, v50
    v_min_f32 v52, s66, v52
    v_min_f32 v54, s66, v54
    v_min_f32 v49, s66, v49
    v_min_f32 v51, s66, v51
    v_min_f32 v53, s66, v53
    v_min_f32 v55, s66, v55
    v_exp_f32 v48, v48
    v_exp_f32 v50, v50
    v_exp_f32 v52, v52
    v_exp_f32 v54, v54
    v_exp_f32 v49, v49
    v_exp_f32 v51, v51
    v_exp_f32 v53, v53
    v_exp_f32 v55, v55
    v_pk_add_f32 v[56:57], v[48:49], 2.0 op_sel_hi:[1,0]
    v_pk_add_f32 v[58:59], v[50:51], 2.0 op_sel_hi:[1,0]
    v_pk_add_f32 v[60:61], v[52:53], 2.0 op_sel_hi:[1,0]
    v_pk_add_f32 v[62:63], v[54:55], 2.0 op_sel_hi:[1,0]
    v_pk_mul_f32 v[56:57], v[48:49], v[56:57]
    v_pk_mul_f32 v[58:59], v[50:51], v[58:59]
    v_pk_mul_f32 v[60:61], v[52:53], v[60:61]
    v_pk_mul_f32 v[62:63], v[54:55], v[62:63]
    v_pk_add_f32 v[48:49], v[56:57], 2.0 op_sel_hi:[1,0]
    v_pk_add_f32 v[50:51], v[58:59], 2.0 op_sel_hi:[1,0]
    v_pk_add_f32 v[52:53], v[60:61], 2.0 op_sel_hi:[1,0]
    v_pk_add_f32 v[54:55], v[62:63], 2.0 op_sel_hi:[1,0]
    v_rcp_f32 v48, v48
    v_rcp_f32 v50, v50
    v_rcp_f32 v52, v52
    v_rcp_f32 v54, v54
    v_rcp_f32 v49, v49
    v_rcp_f32 v51, v51
    v_rcp_f32 v53, v53
    v_rcp_f32 v55, v55
    v_pk_mul_f32 v[48:49], v[56:57], v[48:49]
    v_pk_mul_f32 v[50:51], v[58:59], v[50:51]
    v_pk_mul_f32 v[52:53], v[60:61], v[52:53]
    v_pk_mul_f32 v[54:55], v[62:63], v[54:55]
    v_pk_mul_f32 v[48:49], v[96:97], v[48:49]
    v_pk_mul_f32 v[50:51], v[98:99], v[50:51]
    v_pk_mul_f32 v[52:53], v[100:101], v[52:53]
    v_pk_mul_f32 v[54:55], v[102:103], v[54:55]
    v_cvt_pk_bf16_f32 v56, v48, v49
    v_cvt_pk_bf16_f32 v57, v50, v51
    v_cvt_pk_bf16_f32 v58, v52, v53
    v_cvt_pk_bf16_f32 v59, v54, v55
    v_xor_b32 v60, 0, v11
    v_xor_b32 v61, 16, v11
    ds_write_b64 v60, v[56:57] offset:0
    ds_write_b64 v61, v[58:59] offset:0
    v_pk_mul_f32 v[48:49], v[104:105], s[44:45]
    v_pk_mul_f32 v[50:51], v[106:107], s[44:45]
    v_pk_mul_f32 v[52:53], v[108:109], s[44:45]
    v_pk_mul_f32 v[54:55], v[110:111], s[44:45]
    v_min_f32 v48, s66, v48
    v_min_f32 v50, s66, v50
    v_min_f32 v52, s66, v52
    v_min_f32 v54, s66, v54
    v_min_f32 v49, s66, v49
    v_min_f32 v51, s66, v51
    v_min_f32 v53, s66, v53
    v_min_f32 v55, s66, v55
    v_exp_f32 v48, v48
    v_exp_f32 v50, v50
    v_exp_f32 v52, v52
    v_exp_f32 v54, v54
    v_exp_f32 v49, v49
    v_exp_f32 v51, v51
    v_exp_f32 v53, v53
    v_exp_f32 v55, v55
    v_pk_add_f32 v[56:57], v[48:49], 2.0 op_sel_hi:[1,0]
    v_pk_add_f32 v[58:59], v[50:51], 2.0 op_sel_hi:[1,0]
    v_pk_add_f32 v[60:61], v[52:53], 2.0 op_sel_hi:[1,0]
    v_pk_add_f32 v[62:63], v[54:55], 2.0 op_sel_hi:[1,0]
    v_pk_mul_f32 v[56:57], v[48:49], v[56:57]
    v_pk_mul_f32 v[58:59], v[50:51], v[58:59]
    v_pk_mul_f32 v[60:61], v[52:53], v[60:61]
    v_pk_mul_f32 v[62:63], v[54:55], v[62:63]
    v_pk_add_f32 v[48:49], v[56:57], 2.0 op_sel_hi:[1,0]
    v_pk_add_f32 v[50:51], v[58:59], 2.0 op_sel_hi:[1,0]
    v_pk_add_f32 v[52:53], v[60:61], 2.0 op_sel_hi:[1,0]
    v_pk_add_f32 v[54:55], v[62:63], 2.0 op_sel_hi:[1,0]
    v_rcp_f32 v48, v48
    v_rcp_f32 v50, v50
    v_rcp_f32 v52, v52
    v_rcp_f32 v54, v54
    v_rcp_f32 v49, v49
    v_rcp_f32 v51, v51
    v_rcp_f32 v53, v53
    v_rcp_f32 v55, v55
    v_pk_mul_f32 v[48:49], v[56:57], v[48:49]
    v_pk_mul_f32 v[50:51], v[58:59], v[50:51]
    v_pk_mul_f32 v[52:53], v[60:61], v[52:53]
    v_pk_mul_f32 v[54:55], v[62:63], v[54:55]
    v_pk_mul_f32 v[48:49], v[104:105], v[48:49]
    v_pk_mul_f32 v[50:51], v[106:107], v[50:51]
    v_pk_mul_f32 v[52:53], v[108:109], v[52:53]
    v_pk_mul_f32 v[54:55], v[110:111], v[54:55]
    v_cvt_pk_bf16_f32 v56, v48, v49
    v_cvt_pk_bf16_f32 v57, v50, v51
    v_cvt_pk_bf16_f32 v58, v52, v53
    v_cvt_pk_bf16_f32 v59, v54, v55
    v_xor_b32 v60, 32, v11
    v_xor_b32 v61, 48, v11
    ds_write_b64 v60, v[56:57] offset:0
    ds_write_b64 v61, v[58:59] offset:0
    v_pk_mul_f32 v[48:49], v[112:113], s[44:45]
    v_pk_mul_f32 v[50:51], v[114:115], s[44:45]
    v_pk_mul_f32 v[52:53], v[116:117], s[44:45]
    v_pk_mul_f32 v[54:55], v[118:119], s[44:45]
    v_min_f32 v48, s66, v48
    v_min_f32 v50, s66, v50
    v_min_f32 v52, s66, v52
    v_min_f32 v54, s66, v54
    v_min_f32 v49, s66, v49
    v_min_f32 v51, s66, v51
    v_min_f32 v53, s66, v53
    v_min_f32 v55, s66, v55
    v_exp_f32 v48, v48
    v_exp_f32 v50, v50
    v_exp_f32 v52, v52
    v_exp_f32 v54, v54
    v_exp_f32 v49, v49
    v_exp_f32 v51, v51
    v_exp_f32 v53, v53
    v_exp_f32 v55, v55
    v_pk_add_f32 v[56:57], v[48:49], 2.0 op_sel_hi:[1,0]
    v_pk_add_f32 v[58:59], v[50:51], 2.0 op_sel_hi:[1,0]
    v_pk_add_f32 v[60:61], v[52:53], 2.0 op_sel_hi:[1,0]
    v_pk_add_f32 v[62:63], v[54:55], 2.0 op_sel_hi:[1,0]
    v_pk_mul_f32 v[56:57], v[48:49], v[56:57]
    v_pk_mul_f32 v[58:59], v[50:51], v[58:59]
    v_pk_mul_f32 v[60:61], v[52:53], v[60:61]
    v_pk_mul_f32 v[62:63], v[54:55], v[62:63]
    v_pk_add_f32 v[48:49], v[56:57], 2.0 op_sel_hi:[1,0]
    v_pk_add_f32 v[50:51], v[58:59], 2.0 op_sel_hi:[1,0]
    v_pk_add_f32 v[52:53], v[60:61], 2.0 op_sel_hi:[1,0]
    v_pk_add_f32 v[54:55], v[62:63], 2.0 op_sel_hi:[1,0]
    v_rcp_f32 v48, v48
    v_rcp_f32 v50, v50
    v_rcp_f32 v52, v52
    v_rcp_f32 v54, v54
    v_rcp_f32 v49, v49
    v_rcp_f32 v51, v51
    v_rcp_f32 v53, v53
    v_rcp_f32 v55, v55
    v_pk_mul_f32 v[48:49], v[56:57], v[48:49]
    v_pk_mul_f32 v[50:51], v[58:59], v[50:51]
    v_pk_mul_f32 v[52:53], v[60:61], v[52:53]
    v_pk_mul_f32 v[54:55], v[62:63], v[54:55]
    v_pk_mul_f32 v[48:49], v[112:113], v[48:49]
    v_pk_mul_f32 v[50:51], v[114:115], v[50:51]
    v_pk_mul_f32 v[52:53], v[116:117], v[52:53]
    v_pk_mul_f32 v[54:55], v[118:119], v[54:55]
    v_cvt_pk_bf16_f32 v56, v48, v49
    v_cvt_pk_bf16_f32 v57, v50, v51
    v_cvt_pk_bf16_f32 v58, v52, v53
    v_cvt_pk_bf16_f32 v59, v54, v55
    v_xor_b32 v60, 64, v11
    v_xor_b32 v61, 80, v11
    ds_write_b64 v60, v[56:57] offset:0
    ds_write_b64 v61, v[58:59] offset:0
    v_pk_mul_f32 v[48:49], v[120:121], s[44:45]
    v_pk_mul_f32 v[50:51], v[122:123], s[44:45]
    v_pk_mul_f32 v[52:53], v[124:125], s[44:45]
    v_pk_mul_f32 v[54:55], v[126:127], s[44:45]
    v_min_f32 v48, s66, v48
    v_min_f32 v50, s66, v50
    v_min_f32 v52, s66, v52
    v_min_f32 v54, s66, v54
    v_min_f32 v49, s66, v49
    v_min_f32 v51, s66, v51
    v_min_f32 v53, s66, v53
    v_min_f32 v55, s66, v55
    v_exp_f32 v48, v48
    v_exp_f32 v50, v50
    v_exp_f32 v52, v52
    v_exp_f32 v54, v54
    v_exp_f32 v49, v49
    v_exp_f32 v51, v51
    v_exp_f32 v53, v53
    v_exp_f32 v55, v55
    v_pk_add_f32 v[56:57], v[48:49], 2.0 op_sel_hi:[1,0]
    v_pk_add_f32 v[58:59], v[50:51], 2.0 op_sel_hi:[1,0]
    v_pk_add_f32 v[60:61], v[52:53], 2.0 op_sel_hi:[1,0]
    v_pk_add_f32 v[62:63], v[54:55], 2.0 op_sel_hi:[1,0]
    v_pk_mul_f32 v[56:57], v[48:49], v[56:57]
    v_pk_mul_f32 v[58:59], v[50:51], v[58:59]
    v_pk_mul_f32 v[60:61], v[52:53], v[60:61]
    v_pk_mul_f32 v[62:63], v[54:55], v[62:63]
    v_pk_add_f32 v[48:49], v[56:57], 2.0 op_sel_hi:[1,0]
    v_pk_add_f32 v[50:51], v[58:59], 2.0 op_sel_hi:[1,0]
    v_pk_add_f32 v[52:53], v[60:61], 2.0 op_sel_hi:[1,0]
    v_pk_add_f32 v[54:55], v[62:63], 2.0 op_sel_hi:[1,0]
    v_rcp_f32 v48, v48
    v_rcp_f32 v50, v50
    v_rcp_f32 v52, v52
    v_rcp_f32 v54, v54
    v_rcp_f32 v49, v49
    v_rcp_f32 v51, v51
    v_rcp_f32 v53, v53
    v_rcp_f32 v55, v55
    v_pk_mul_f32 v[48:49], v[56:57], v[48:49]
    v_pk_mul_f32 v[50:51], v[58:59], v[50:51]
    v_pk_mul_f32 v[52:53], v[60:61], v[52:53]
    v_pk_mul_f32 v[54:55], v[62:63], v[54:55]
    v_pk_mul_f32 v[48:49], v[120:121], v[48:49]
    v_pk_mul_f32 v[50:51], v[122:123], v[50:51]
    v_pk_mul_f32 v[52:53], v[124:125], v[52:53]
    v_pk_mul_f32 v[54:55], v[126:127], v[54:55]
    v_cvt_pk_bf16_f32 v56, v48, v49
    v_cvt_pk_bf16_f32 v57, v50, v51
    v_cvt_pk_bf16_f32 v58, v52, v53
    v_cvt_pk_bf16_f32 v59, v54, v55
    v_xor_b32 v60, 96, v11
    v_xor_b32 v61, 112, v11
    ds_write_b64 v60, v[56:57] offset:0
    ds_write_b64 v61, v[58:59] offset:0
    s_lshr_b32 s38, s6, 1
    s_lshl_b32 s39, s33, 1
    s_add_u32 s38, s38, s39
    s_mul_i32 s38, s38, 229376
    s_lshl_b32 s39, s34, 14
    s_add_u32 s38, s38, s39
    s_and_b32 s39, s6, 1
    s_lshl_b32 s39, s39, 12
    s_add_u32 s38, s38, s39
    s_add_u32 s71, s38, 13639680
    s_mov_b32 s75, s71
    s_waitcnt lgkmcnt(0)
    ds_read_b128 v[48:51], v12 offset:0
    ds_read_b128 v[52:55], v12 offset:1024
    ds_read_b128 v[56:59], v12 offset:2048
    ds_read_b128 v[60:63], v12 offset:3072
    s_waitcnt lgkmcnt(3)
    buffer_store_dwordx4 v[48:51], v13, s[24:27], s71 offen offset:0 sc1
    s_waitcnt lgkmcnt(2)
    buffer_store_dwordx4 v[52:55], v13, s[24:27], s71 offen offset:1024 sc1
    s_waitcnt lgkmcnt(1)
    buffer_store_dwordx4 v[56:59], v13, s[24:27], s71 offen offset:2048 sc1
    s_waitcnt lgkmcnt(0)
    buffer_store_dwordx4 v[60:63], v13, s[24:27], s71 offen offset:3072 sc1
    s_branch K_g2
K_idleG1:
    s_sub_u32 s63, s5, 28
    s_lshl_b32 s55, s4, 2
    s_add_u32 s63, s63, s55
    s_mov_b32 s12, s96
    s_and_b32 s13, s97, 0xffff
    s_mov_b32 s14, 1052672
    s_mov_b32 s15, 131072
    s_mov_b32 s16, s98
    s_and_b32 s17, s99, 0xffff
    s_mov_b32 s18, 1052672
    s_mov_b32 s19, 131072
    v_lshlrev_b32 v98, 4, v1
    s_mul_i32 s29, s63, 32896
    s_lshl_b32 s30, s6, 10
    s_add_u32 s29, s29, s30
    s_add_u32 m0, s30, 0
    s_mov_b32 s31, s29
    buffer_load_dwordx4 v98, s[12:15], s31 offen  lds
    s_add_u32 m0, m0, 4096
    s_add_u32 s31, s31, 4096
    buffer_load_dwordx4 v98, s[12:15], s31 offen  lds
    s_add_u32 m0, m0, 4096
    s_add_u32 s31, s31, 4096
    buffer_load_dwordx4 v98, s[12:15], s31 offen  lds
    s_add_u32 m0, m0, 4096
    s_add_u32 s31, s31, 4096
    buffer_load_dwordx4 v98, s[12:15], s31 offen  lds
    s_add_u32 m0, m0, 4096
    s_add_u32 s31, s31, 4096
    buffer_load_dwordx4 v98, s[12:15], s31 offen  lds
    s_add_u32 m0, m0, 4096
    s_add_u32 s31, s31, 4096
    buffer_load_dwordx4 v98, s[12:15], s31 offen  lds
    s_add_u32 m0, m0, 4096
    s_add_u32 s31, s31, 4096
    buffer_load_dwordx4 v98, s[12:15], s31 offen  lds
    s_add_u32 m0, m0, 4096
    s_add_u32 s31, s31, 4096
    buffer_load_dwordx4 v98, s[12:15], s31 offen  lds
    s_add_u32 m0, s30, 33792
    s_mov_b32 s31, s29
    buffer_load_dwordx4 v98, s[16:19], s31 offen  lds
    s_add_u32 m0, m0, 4096
    s_add_u32 s31, s31, 4096
    buffer_load_dwordx4 v98, s[16:19], s31 offen  lds
    s_add_u32 m0, m0, 4096
    s_add_u32 s31, s31, 4096
    buffer_load_dwordx4 v98, s[16:19], s31 offen  lds
    s_add_u32 m0, m0, 4096
    s_add_u32 s31, s31, 4096
    buffer_load_dwordx4 v98, s[16:19], s31 offen  lds
    s_add_u32 m0, m0, 4096
    s_add_u32 s31, s31, 4096
    buffer_load_dwordx4 v98, s[16:19], s31 offen  lds
    s_add_u32 m0, m0, 4096
    s_add_u32 s31, s31, 4096
    buffer_load_dwordx4 v98, s[16:19], s31 offen  lds
    s_add_u32 m0, m0, 4096
    s_add_u32 s31, s31, 4096
    buffer_load_dwordx4 v98, s[16:19], s31 offen  lds
    s_add_u32 m0, m0, 4096
    s_add_u32 s31, s31, 4096
    buffer_load_dwordx4 v98, s[16:19], s31 offen  lds
    s_cmp_lg_u32 s6, 0
    s_cbranch_scc1 K_p91
    s_add_u32 s31, s29, 32768
    s_mov_b32 m0, 32768
    s_nop 0
    buffer_load_dwordx4 v98, s[12:15], s31 offen lds
    s_mov_b32 m0, 66560
    s_nop 0
    buffer_load_dwordx4 v98, s[16:19], s31 offen lds
K_p91:
    s_lshl_b32 s45, s63, 6
    v_add_u32 v4, s45, v1
    v_sub_u32 v5, 2048, v4
    v_and_b32 v5, 2047, v5
    v_mul_u32_u24 v4, 514, v4
    v_mul_u32_u24 v5, 514, v5
    s_cmp_lg_u32 s6, 3
    s_cbranch_scc1 K_pg2
    buffer_load_ushort v72, v4, s[12:15], 0 offen offset:0
    buffer_load_ushort v73, v5, s[12:15], 0 offen offset:0
    buffer_load_ushort v74, v4, s[12:15], 0 offen offset:512
    buffer_load_ushort v75, v5, s[12:15], 0 offen offset:512
    buffer_load_ushort v76, v4, s[16:19], 0 offen offset:0
    buffer_load_ushort v77, v5, s[16:19], 0 offen offset:0
    buffer_load_ushort v78, v4, s[16:19], 0 offen offset:512
    buffer_load_ushort v79, v5, s[16:19], 0 offen offset:512
K_pg2:
    v_and_b32 v5, 15, v1
    v_lshrrev_b32 v6, 4, v1
    v_mul_u32_u24 v96, 2056, v5
    s_lshl_b32 s29, s6, 7
    v_lshl_add_u32 v96, v6, 1, v96
    v_add_u32 v96, s29, v96
    v_mul_u32_u24 v97, 8320, v6
    v_lshl_add_u32 v97, v5, 4, v97
    s_lshl_b32 s29, s6, 6
    s_mul_i32 s29, s29, 8320
    s_lshl_b32 s30, s63, 8
    s_add_u32 s29, s29, s30
    s_add_u32 s42, s29, 4194304
    s_mov_b32 s43, 0
    s_waitcnt vmcnt(0)
    s_barrier
K_pql:
    ds_read_u16 v8, v96 offset:0
    ds_read_u16 v12, v96 offset:33792
    ds_read_u16 v9, v96 offset:514
    ds_read_u16 v13, v96 offset:34306
    ds_read_u16 v10, v96 offset:1028
    ds_read_u16 v14, v96 offset:34820
    ds_read_u16 v11, v96 offset:1542
    ds_read_u16 v15, v96 offset:35334
    ds_read_u16 v20, v96 offset:8
    ds_read_u16 v24, v96 offset:33800
    ds_read_u16 v21, v96 offset:522
    ds_read_u16 v25, v96 offset:34314
    ds_read_u16 v22, v96 offset:1036
    ds_read_u16 v26, v96 offset:34828
    ds_read_u16 v23, v96 offset:1550
    ds_read_u16 v27, v96 offset:35342
    ds_read_u16 v32, v96 offset:16
    ds_read_u16 v36, v96 offset:33808
    ds_read_u16 v33, v96 offset:530
    ds_read_u16 v37, v96 offset:34322
    ds_read_u16 v34, v96 offset:1044
    ds_read_u16 v38, v96 offset:34836
    ds_read_u16 v35, v96 offset:1558
    ds_read_u16 v39, v96 offset:35350
    ds_read_u16 v44, v96 offset:24
    ds_read_u16 v48, v96 offset:33816
    ds_read_u16 v45, v96 offset:538
    ds_read_u16 v49, v96 offset:34330
    ds_read_u16 v46, v96 offset:1052
    ds_read_u16 v50, v96 offset:34844
    ds_read_u16 v47, v96 offset:1566
    ds_read_u16 v51, v96 offset:35358
    s_waitcnt lgkmcnt(15)
    v_lshl_or_b32 v16, v12, 16, v8
    v_lshl_or_b32 v17, v13, 16, v9
    v_lshl_or_b32 v18, v14, 16, v10
    v_lshl_or_b32 v19, v15, 16, v11
    buffer_store_dwordx4 v[16:19], v97, s[24:27], s42 offen sc1
    s_add_u32 s42, s42, 33280
    s_waitcnt lgkmcnt(15)
    v_lshl_or_b32 v28, v24, 16, v20
    v_lshl_or_b32 v29, v25, 16, v21
    v_lshl_or_b32 v30, v26, 16, v22
    v_lshl_or_b32 v31, v27, 16, v23
    buffer_store_dwordx4 v[28:31], v97, s[24:27], s42 offen sc1
    s_add_u32 s42, s42, 33280
    s_waitcnt lgkmcnt(8)
    v_lshl_or_b32 v40, v36, 16, v32
    v_lshl_or_b32 v41, v37, 16, v33
    v_lshl_or_b32 v42, v38, 16, v34
    v_lshl_or_b32 v43, v39, 16, v35
    buffer_store_dwordx4 v[40:43], v97, s[24:27], s42 offen sc1
    s_add_u32 s42, s42, 33280
    s_waitcnt lgkmcnt(0)
    v_lshl_or_b32 v52, v48, 16, v44
    v_lshl_or_b32 v53, v49, 16, v45
    v_lshl_or_b32 v54, v50, 16, v46
    v_lshl_or_b32 v55, v51, 16, v47
    buffer_store_dwordx4 v[52:55], v97, s[24:27], s42 offen sc1
    s_add_u32 s42, s42, 33280
    v_add_u32 v96, 32, v96
    s_add_u32 s43, s43, 1
    s_cmp_lt_u32 s43, 4
    s_cbranch_scc1 K_pql
    s_cmp_lg_u32 s6, 3
    s_cbranch_scc1 K_pa3
    v_lshlrev_b32 v72, 16, v72
    v_lshlrev_b32 v73, 16, v73
    v_lshlrev_b32 v74, 16, v74
    v_lshlrev_b32 v75, 16, v75
    v_lshlrev_b32 v76, 16, v76
    v_lshlrev_b32 v77, 16, v77
    v_lshlrev_b32 v78, 16, v78
    v_lshlrev_b32 v79, 16, v79
    v_add_f32 v56, v72, v73
    v_add_f32 v57, v74, v75
    v_sub_f32 v58, v76, v77
    v_sub_f32 v59, v78, v79
    v_add_f32 v60, v56, v57
    v_add_f32 v61, v58, v59
    v_sub_f32 v62, v56, v57
    v_sub_f32 v63, v58, v59
    v_mul_f32 v60, 0x3e800000, v60
    v_mul_f32 v61, 0x3e800000, v61
    v_mul_f32 v62, 0x3e800000, v62
    v_mul_f32 v63, 0x3e800000, v63
    v_cvt_pk_bf16_f32 v60, v60, v61
    v_cvt_pk_bf16_f32 v62, v62, v63
    v_lshlrev_b32 v64, 2, v1
    s_lshl_b32 s29, s63, 8
    s_add_u32 s29, s29, 6324224
    s_add_u32 s30, s29, 8320
    buffer_store_dword v60, v64, s[24:27], s29 offen sc1
    buffer_store_dword v62, v64, s[24:27], s30 offen sc1
K_pa3:
    s_waitcnt lgkmcnt(0)
    s_add_u32 s32, s32, 1
    s_waitcnt vmcnt(0)
    s_barrier
    s_cmp_eq_u32 s6, 0
    s_cselect_b32 s39, 0, 0x7ff00000
    s_lshl_b32 s38, s63, 7
    s_add_u32 s38, s38, 32768
    v_mov_b32 v14, s32
    v_mov_b32 v15, s39
    s_mov_b64 s[46:47], exec
    s_mov_b64 exec, 1
    buffer_store_dword v14, v15, s[24:27], s38 offen sc0 sc1
    s_mov_b64 exec, s[46:47]
    s_load_dwordx4 s[60:63], s[0:1], 40
    s_load_dwordx2 s[64:65], s[0:1], 64
    s_waitcnt lgkmcnt(0)
    s_mov_b32 s16, s60
    s_and_b32 s17, s61, 0xffff
    s_mov_b32 s18, 3584
    s_mov_b32 s19, 131072
    s_mov_b32 s20, s62
    s_and_b32 s21, s63, 0xffff
    s_mov_b32 s22, 1835008
    s_mov_b32 s23, 131072
    s_mov_b32 s28, s64
    s_and_b32 s29, s65, 0xffff
    s_mov_b32 s30, 2097152
    s_mov_b32 s31, 131072
    s_sub_u32 s40, s5, 28
    s_lshl_b32 s41, s4, 2
    s_add_u32 s40, s40, s41
    s_lshr_b32 s41, s40, 1
    s_lshl_b32 s41, s41, 4
    s_and_b32 s40, s40, 1
    s_add_u32 s40, s40, s41
    s_add_u32 s73, s40, 14
    s_mov_b32 s7, 1
    s_lshl_b32 s48, s4, 2
    s_and_b32 s38, s5, 3
    s_add_u32 s48, s48, s38
    s_lshr_b32 s49, s5, 2
    s_mul_i32 s39, s49, 7
    s_lshr_b32 s39, s39, 2
    s_mul_i32 s38, s38, 3
    s_add_u32 s50, s39, s38
    s_cmp_ge_u32 s50, 14
    s_cselect_b32 s38, 14, 0
    s_sub_u32 s50, s50, s38
    s_cmp_ge_u32 s50, 14
    s_cselect_b32 s38, 14, 0
    s_sub_u32 s50, s50, s38
    s_mov_b32 s51, 0
    s_mov_b32 s52, 0
    s_mul_i32 s53, s48, 229376
    s_lshl_b32 s38, s6, 11
    s_add_u32 s53, s53, s38
    s_add_u32 s53, s53, 13631488
    s_lshl_b32 s54, s6, 14
    s_lshl_b32 s38, s49, 7
    s_add_u32 s54, s54, s38
    s_lshl_b32 s68, s6, 11
    v_lshrrev_b32 v15, 4, v1
    v_and_b32 v16, 7, v1
    v_xor_b32 v14, v16, v15
    v_lshlrev_b32 v14, 4, v14
    v_lshrrev_b32 v17, 3, v1
    v_lshl_add_u32 v2, v17, 7, v14
    v_add_u32 v15, 4, v15
    v_xor_b32 v14, v16, v15
    v_lshlrev_b32 v14, 4, v14
    v_lshl_add_u32 v3, v17, 7, v14
    v_bfe_u32 v15, v1, 4, 1
    v_lshlrev_b32 v15, 2, v15
    v_and_b32 v16, 7, v1
    v_xor_b32 v16, v16, v15
    v_lshlrev_b32 v16, 4, v16
    v_lshrrev_b32 v17, 3, v1
    v_mul_u32_u24 v17, 1024, v17
    v_add_u32 v4, v16, v17
    s_lshr_b32 s38, s6, 1
    s_lshl_b32 s38, s38, 12
    v_and_b32 v14, 31, v1
    v_lshrrev_b32 v15, 5, v1
    v_bfe_u32 v16, v14, 1, 3
    v_lshlrev_b32 v14, 7, v14
    v_add_u32 v14, s38, v14
    v_add_u32 v17, 0, v15
    v_xor_b32 v17, v17, v16
    v_lshl_add_u32 v5, v17, 4, v14
    v_add_u32 v17, 2, v15
    v_xor_b32 v17, v17, v16
    v_lshl_add_u32 v6, v17, 4, v14
    v_add_u32 v17, 4, v15
    v_xor_b32 v17, v17, v16
    v_lshl_add_u32 v7, v17, 4, v14
    v_add_u32 v17, 6, v15
    v_xor_b32 v17, v17, v16
    v_lshl_add_u32 v8, v17, 4, v14
    s_and_b32 s39, s6, 1
    v_lshrrev_b32 v14, 5, v1
    v_lshlrev_b32 v14, 3, v14
    v_bfe_u32 v15, v1, 2, 2
    v_add_u32 v14, v14, v15
    v_lshlrev_b32 v14, 7, v14
    v_bfe_u32 v15, v1, 3, 1
    v_xor_b32 v15, s39, v15
    v_lshl_add_u32 v14, v15, 6, v14
    v_bfe_u32 v15, v1, 4, 1
    v_lshl_add_u32 v14, v15, 5, v14
    v_and_b32 v15, 3, v1
    v_lshl_add_u32 v14, v15, 3, v14
    v_add_u32 v9, 32768, v14
    s_waitcnt vmcnt(0)
    s_branch K_pre
K_dummy:
    v_mov_b32 v16, 0x7ff00000
    buffer_store_dwordx4 v[48:51], v16, s[24:27], 0 offen sc1
    buffer_store_dwordx4 v[48:51], v16, s[24:27], 0 offen sc1
    buffer_store_dwordx4 v[48:51], v16, s[24:27], 0 offen sc1
    buffer_store_dwordx4 v[48:51], v16, s[24:27], 0 offen sc1
K_g2:
    s_waitcnt vmcnt(4)
    s_mov_b32 s39, 0
K_fl4:
    v_cmp_ne_u32 vcc, s32, v15
    s_nop 0
    s_and_b64 vcc, vcc, s[56:57]
    s_cbranch_vccz K_fd5
    s_cmp_ge_u32 s39, 32768
    s_cbranch_scc1 K_fd5
    s_sleep 3
    buffer_load_dword v15, v14, s[24:27], s60 offen sc0 sc1
    s_add_u32 s39, s39, 1
    s_waitcnt vmcnt(0)
    s_branch K_fl4
K_fd5:
    s_lshl_b32 s69, s50, 14
    s_add_u32 s69, s69, s53
    s_add_u32 m0, s68, 0
    s_add_u32 s50, s50, 1
    buffer_load_dwordx4 v2, s[24:27], s69 offen sc1 lds
    s_cmp_eq_u32 s50, 14
    buffer_load_dwordx4 v3, s[24:27], s69 offen offset:1024 sc1 lds
    s_cselect_b32 s50, 0, s50
    s_lshl_b32 s69, s50, 14
    s_add_u32 s69, s69, s53
    s_add_u32 m0, s68, 8192
    s_add_u32 s50, s50, 1
    buffer_load_dwordx4 v2, s[24:27], s69 offen sc1 lds
    s_cmp_eq_u32 s50, 14
    buffer_load_dwordx4 v3, s[24:27], s69 offen offset:1024 sc1 lds
    s_cselect_b32 s50, 0, s50
    s_lshl_b32 s69, s50, 14
    s_add_u32 s69, s69, s53
    s_add_u32 m0, s68, 16384
    s_add_u32 s50, s50, 1
    buffer_load_dwordx4 v2, s[24:27], s69 offen sc1 lds
    s_cmp_eq_u32 s50, 14
    buffer_load_dwordx4 v3, s[24:27], s69 offen offset:1024 sc1 lds
    s_cselect_b32 s50, 0, s50
    s_lshl_b32 s69, s50, 14
    s_add_u32 s69, s69, s53
    s_add_u32 m0, s68, 24576
    s_add_u32 s50, s50, 1
    buffer_load_dwordx4 v2, s[24:27], s69 offen sc1 lds
    s_cmp_eq_u32 s50, 14
    buffer_load_dwordx4 v3, s[24:27], s69 offen offset:1024 sc1 lds
    s_cselect_b32 s50, 0, s50
    s_waitcnt vmcnt(6)
    s_barrier
    s_cmp_eq_u32 s6, 0
    s_cselect_b32 s39, 0, 0x7ff00000
    s_lshl_b32 s38, s73, 7
    s_add_u32 s38, s38, 98304
    v_mov_b32 v14, s32
    v_mov_b32 v15, s39
    s_mov_b64 s[46:47], exec
    s_mov_b64 exec, 1
    buffer_store_dword v14, v15, s[24:27], s38 offen sc0 sc1
    s_mov_b64 exec, s[46:47]
    ds_read_b64_tr_b16 v[16:17], v9 offset:0
    ds_read_b64_tr_b16 v[18:19], v9 offset:512
    ds_read_b128 v[20:23], v5 offset:0
    ds_read_b64_tr_b16 v[24:25], v9 offset:2048
    ds_read_b64_tr_b16 v[26:27], v9 offset:2560
    ds_read_b128 v[28:31], v6 offset:0
    ds_read_b64_tr_b16 v[32:33], v9 offset:4096
    ds_read_b64_tr_b16 v[34:35], v9 offset:4608
    ds_read_b128 v[36:39], v7 offset:0
    ds_read_b64_tr_b16 v[40:41], v9 offset:6144
    ds_read_b64_tr_b16 v[42:43], v9 offset:6656
    ds_read_b128 v[44:47], v8 offset:0
    s_waitcnt vmcnt(5) lgkmcnt(0)
    s_barrier
    v_mfma_f32_32x32x16_bf16 v[96:111], v[16:19], v[20:23], 0
    ds_read_b64_tr_b16 v[48:49], v9 offset:8192
    ds_read_b64_tr_b16 v[50:51], v9 offset:8704
    ds_read_b128 v[52:55], v5 offset:8192
    s_lshl_b32 s38, s50, 1
    s_add_u32 s38, s38, s51
    s_lshl_b32 s69, s38, 13
    s_add_u32 s69, s69, s53
    s_lshl_b32 s70, s38, 16
    s_add_u32 m0, s68, 0
    s_nop 0
    buffer_load_dwordx4 v2, s[24:27], s69 offen sc1 lds
    v_mfma_f32_32x32x16_bf16 v[96:111], v[24:27], v[28:31], v[96:111]
    ds_read_b64_tr_b16 v[56:57], v9 offset:10240
    ds_read_b64_tr_b16 v[58:59], v9 offset:10752
    ds_read_b128 v[60:63], v6 offset:8192
    s_add_u32 s70, s70, s54
    s_add_u32 s50, s50, 1
    buffer_load_dwordx4 v3, s[24:27], s69 offen offset:1024 sc1 lds
    v_mfma_f32_32x32x16_bf16 v[96:111], v[32:35], v[36:39], v[96:111]
    ds_read_b64_tr_b16 v[64:65], v9 offset:12288
    ds_read_b64_tr_b16 v[66:67], v9 offset:12800
    ds_read_b128 v[68:71], v7 offset:8192
    s_add_u32 m0, s68, 32768
    s_cmp_eq_u32 s50, 14
    buffer_load_dwordx4 v4, s[20:23], s70 offen  lds
    v_mfma_f32_32x32x16_bf16 v[96:111], v[40:43], v[44:47], v[96:111]
    ds_read_b64_tr_b16 v[72:73], v9 offset:14336
    ds_read_b64_tr_b16 v[74:75], v9 offset:14848
    ds_read_b128 v[76:79], v8 offset:8192
    s_cselect_b32 s50, 0, s50
    s_add_u32 s70, s70, 7168
    buffer_load_dwordx4 v4, s[20:23], s70 offen offset:1024  lds
    s_waitcnt vmcnt(7) lgkmcnt(0)
    s_barrier
    v_mfma_f32_32x32x16_bf16 v[96:111], v[48:51], v[52:55], v[96:111]
    ds_read_b64_tr_b16 v[16:17], v9 offset:16384
    ds_read_b64_tr_b16 v[18:19], v9 offset:16896
    ds_read_b128 v[20:23], v5 offset:16384
    s_lshl_b32 s38, s50, 1
    s_add_u32 s38, s38, s51
    s_lshl_b32 s69, s38, 13
    s_add_u32 s69, s69, s53
    s_lshl_b32 s70, s38, 16
    s_add_u32 m0, s68, 8192
    s_nop 0
    buffer_load_dwordx4 v2, s[24:27], s69 offen sc1 lds
    v_mfma_f32_32x32x16_bf16 v[96:111], v[56:59], v[60:63], v[96:111]
    ds_read_b64_tr_b16 v[24:25], v9 offset:18432
    ds_read_b64_tr_b16 v[26:27], v9 offset:18944
    ds_read_b128 v[28:31], v6 offset:16384
    s_add_u32 s70, s70, s54
    s_add_u32 s50, s50, 1
    buffer_load_dwordx4 v3, s[24:27], s69 offen offset:1024 sc1 lds
    v_mfma_f32_32x32x16_bf16 v[96:111], v[64:67], v[68:71], v[96:111]
    ds_read_b64_tr_b16 v[32:33], v9 offset:20480
    ds_read_b64_tr_b16 v[34:35], v9 offset:20992
    ds_read_b128 v[36:39], v7 offset:16384
    s_add_u32 m0, s68, 40960
    s_cmp_eq_u32 s50, 14
    buffer_load_dwordx4 v4, s[20:23], s70 offen  lds
    v_mfma_f32_32x32x16_bf16 v[96:111], v[72:75], v[76:79], v[96:111]
    ds_read_b64_tr_b16 v[40:41], v9 offset:22528
    ds_read_b64_tr_b16 v[42:43], v9 offset:23040
    ds_read_b128 v[44:47], v8 offset:16384
    s_cselect_b32 s50, 0, s50
    s_add_u32 s70, s70, 7168
    buffer_load_dwordx4 v4, s[20:23], s70 offen offset:1024  lds
    s_and_b32 s38, s6, 1
    s_lshl_b32 s38, s38, 12
    v_and_b32 v90, 31, v1
    v_lshrrev_b32 v91, 5, v1
    v_bfe_u32 v92, v90, 1, 3
    v_lshlrev_b32 v90, 7, v90
    v_add_u32 v90, s38, v90
    v_add_u32 v93, 0, v91
    v_xor_b32 v93, v93, v92
    v_lshl_add_u32 v80, v93, 4, v90
    v_add_u32 v93, 2, v91
    v_xor_b32 v93, v93, v92
    v_lshl_add_u32 v81, v93, 4, v90
    v_add_u32 v93, 4, v91
    v_xor_b32 v93, v93, v92
    v_lshl_add_u32 v82, v93, 4, v90
    v_add_u32 v93, 6, v91
    v_xor_b32 v93, v93, v92
    v_lshl_add_u32 v83, v93, 4, v90
    s_lshr_b32 s39, s6, 1
    v_lshrrev_b32 v90, 5, v1
    v_lshlrev_b32 v90, 3, v90
    v_bfe_u32 v91, v1, 2, 2
    v_add_u32 v90, v90, v91
    v_lshlrev_b32 v90, 7, v90
    v_bfe_u32 v91, v1, 3, 1
    v_xor_b32 v91, s39, v91
    v_lshl_add_u32 v90, v91, 6, v90
    v_bfe_u32 v91, v1, 4, 1
    v_lshl_add_u32 v90, v91, 5, v90
    v_and_b32 v91, 3, v1
    v_lshl_add_u32 v90, v91, 3, v90
    v_add_u32 v84, 32768, v90
    v_lshrrev_b32 v90, 4, v1
    v_mul_u32_u24 v91, 8320, v90
    v_bfe_u32 v92, v1, 3, 1
    v_lshl_add_u32 v91, v92, 12, v91
    v_and_b32 v90, 1, v90
    v_lshlrev_b32 v90, 2, v90
    v_and_b32 v92, 7, v1
    v_xor_b32 v90, v90, v92
    v_lshl_add_u32 v85, v90, 4, v91
    s_lshl_b32 s71, s49, 16
    s_lshl_b32 s38, s6, 11
    s_add_u32 s71, s71, s38
    s_add_u32 s71, s71, 10485760
    s_mul_i32 s72, s6, 66560
    s_lshl_b32 s38, s48, 7
    s_add_u32 s72, s72, s38
    s_add_u32 s72, s72, 7340032
    s_waitcnt vmcnt(9) lgkmcnt(0)
    s_barrier
    v_mfma_f32_32x32x16_bf16 v[96:111], v[16:19], v[20:23], v[96:111]
    ds_read_b64_tr_b16 v[48:49], v9 offset:24576
    ds_read_b64_tr_b16 v[50:51], v9 offset:25088
    ds_read_b128 v[52:55], v5 offset:24576
    s_lshl_b32 s38, s50, 1
    s_add_u32 s38, s38, s51
    s_lshl_b32 s69, s38, 13
    s_add_u32 s69, s69, s53
    s_lshl_b32 s70, s38, 16
    s_add_u32 m0, s68, 16384
    s_nop 0
    buffer_load_dwordx4 v2, s[24:27], s69 offen sc1 lds
    v_mfma_f32_32x32x16_bf16 v[96:111], v[24:27], v[28:31], v[96:111]
    ds_read_b64_tr_b16 v[56:57], v9 offset:26624
    ds_read_b64_tr_b16 v[58:59], v9 offset:27136
    ds_read_b128 v[60:63], v6 offset:24576
    s_add_u32 s70, s70, s54
    s_add_u32 s50, s50, 1
    buffer_load_dwordx4 v3, s[24:27], s69 offen offset:1024 sc1 lds
    v_mfma_f32_32x32x16_bf16 v[96:111], v[32:35], v[36:39], v[96:111]
    ds_read_b64_tr_b16 v[64:65], v9 offset:28672
    ds_read_b64_tr_b16 v[66:67], v9 offset:29184
    ds_read_b128 v[68:71], v7 offset:24576
    s_add_u32 m0, s68, 49152
    s_cmp_eq_u32 s50, 14
    buffer_load_dwordx4 v4, s[20:23], s70 offen  lds
    v_mfma_f32_32x32x16_bf16 v[96:111], v[40:43], v[44:47], v[96:111]
    ds_read_b64_tr_b16 v[72:73], v9 offset:30720
    ds_read_b64_tr_b16 v[74:75], v9 offset:31232
    ds_read_b128 v[76:79], v8 offset:24576
    s_cselect_b32 s50, 0, s50
    s_add_u32 s70, s70, 7168
    buffer_load_dwordx4 v4, s[20:23], s70 offen offset:1024  lds
    s_waitcnt vmcnt(8) lgkmcnt(0)
    s_barrier
    v_mfma_f32_32x32x16_bf16 v[96:111], v[48:51], v[52:55], v[96:111]
    ds_read_b64_tr_b16 v[16:17], v9 offset:0
    ds_read_b64_tr_b16 v[18:19], v9 offset:512
    ds_read_b128 v[20:23], v5 offset:0
    s_lshl_b32 s38, s50, 1
    s_add_u32 s38, s38, s51
    s_lshl_b32 s69, s38, 13
    s_add_u32 s69, s69, s53
    s_lshl_b32 s70, s38, 16
    s_add_u32 m0, s68, 24576
    s_nop 0
    buffer_load_dwordx4 v2, s[24:27], s69 offen sc1 lds
    v_mfma_f32_32x32x16_bf16 v[96:111], v[56:59], v[60:63], v[96:111]
    ds_read_b64_tr_b16 v[24:25], v9 offset:2048
    ds_read_b64_tr_b16 v[26:27], v9 offset:2560
    ds_read_b128 v[28:31], v6 offset:0
    s_add_u32 s70, s70, s54
    s_add_u32 s50, s50, 1
    buffer_load_dwordx4 v3, s[24:27], s69 offen offset:1024 sc1 lds
    v_mfma_f32_32x32x16_bf16 v[96:111], v[64:67], v[68:71], v[96:111]
    ds_read_b64_tr_b16 v[32:33], v9 offset:4096
    ds_read_b64_tr_b16 v[34:35], v9 offset:4608
    ds_read_b128 v[36:39], v7 offset:0
    s_add_u32 m0, s68, 57344
    s_cmp_eq_u32 s50, 14
    buffer_load_dwordx4 v4, s[20:23], s70 offen  lds
    v_mfma_f32_32x32x16_bf16 v[96:111], v[72:75], v[76:79], v[96:111]
    ds_read_b64_tr_b16 v[40:41], v9 offset:6144
    ds_read_b64_tr_b16 v[42:43], v9 offset:6656
    ds_read_b128 v[44:47], v8 offset:0
    s_cselect_b32 s50, 0, s50
    s_add_u32 s70, s70, 7168
    buffer_load_dwordx4 v4, s[20:23], s70 offen offset:1024  lds
    s_mov_b32 s52, 1
K_g2loop:
    s_waitcnt vmcnt(8) lgkmcnt(0)
    s_barrier
    v_mfma_f32_32x32x16_bf16 v[96:111], v[16:19], v[20:23], v[96:111]
    ds_read_b64_tr_b16 v[48:49], v9 offset:8192
    ds_read_b64_tr_b16 v[50:51], v9 offset:8704
    ds_read_b128 v[52:55], v5 offset:8192
    s_lshl_b32 s38, s50, 1
    s_add_u32 s38, s38, s51
    s_lshl_b32 s69, s38, 13
    s_add_u32 s69, s69, s53
    s_lshl_b32 s70, s38, 16
    s_add_u32 m0, s68, 0
    s_nop 0
    buffer_load_dwordx4 v2, s[24:27], s69 offen sc1 lds
    v_mfma_f32_32x32x16_bf16 v[96:111], v[24:27], v[28:31], v[96:111]
    ds_read_b64_tr_b16 v[56:57], v9 offset:10240
    ds_read_b64_tr_b16 v[58:59], v9 offset:10752
    ds_read_b128 v[60:63], v6 offset:8192
    s_add_u32 s70, s70, s54
    s_add_u32 s50, s50, 1
    buffer_load_dwordx4 v3, s[24:27], s69 offen offset:1024 sc1 lds
    v_mfma_f32_32x32x16_bf16 v[96:111], v[32:35], v[36:39], v[96:111]
    ds_read_b64_tr_b16 v[64:65], v9 offset:12288
    ds_read_b64_tr_b16 v[66:67], v9 offset:12800
    ds_read_b128 v[68:71], v7 offset:8192
    s_add_u32 m0, s68, 32768
    s_cmp_eq_u32 s50, 14
    buffer_load_dwordx4 v4, s[20:23], s70 offen  lds
    v_mfma_f32_32x32x16_bf16 v[96:111], v[40:43], v[44:47], v[96:111]
    ds_read_b64_tr_b16 v[72:73], v9 offset:14336
    ds_read_b64_tr_b16 v[74:75], v9 offset:14848
    ds_read_b128 v[76:79], v8 offset:8192
    s_cselect_b32 s50, 0, s50
    s_add_u32 s70, s70, 7168
    buffer_load_dwordx4 v4, s[20:23], s70 offen offset:1024  lds
    s_waitcnt vmcnt(8) lgkmcnt(0)
    s_barrier
    s_cmp_eq_u32 s52, 5
    s_cbranch_scc0 K_iz6
    s_lshl_b32 s43, s4, 8
    v_lshlrev_b32 v13, 2, v1
    v_cmp_gt_u32 s[62:63], 1, v1
    v_mov_b32 v11, 0x7ff00000
    s_add_u32 s61, s43, 26624
    v_cndmask_b32_e64 v13, v11, v13, s[62:63]
    buffer_load_dword v11, v13, s[24:27], s61 offen sc0 sc1
K_iz6:
    v_mfma_f32_32x32x16_bf16 v[96:111], v[48:51], v[52:55], v[96:111]
    ds_read_b64_tr_b16 v[16:17], v9 offset:16384
    ds_read_b64_tr_b16 v[18:19], v9 offset:16896
    ds_read_b128 v[20:23], v5 offset:16384
    s_lshl_b32 s38, s50, 1
    s_add_u32 s38, s38, s51
    s_lshl_b32 s69, s38, 13
    s_add_u32 s69, s69, s53
    s_lshl_b32 s70, s38, 16
    s_add_u32 m0, s68, 8192
    s_nop 0
    buffer_load_dwordx4 v2, s[24:27], s69 offen sc1 lds
    v_mfma_f32_32x32x16_bf16 v[96:111], v[56:59], v[60:63], v[96:111]
    ds_read_b64_tr_b16 v[24:25], v9 offset:18432
    ds_read_b64_tr_b16 v[26:27], v9 offset:18944
    ds_read_b128 v[28:31], v6 offset:16384
    s_add_u32 s70, s70, s54
    s_add_u32 s50, s50, 1
    buffer_load_dwordx4 v3, s[24:27], s69 offen offset:1024 sc1 lds
    v_mfma_f32_32x32x16_bf16 v[96:111], v[64:67], v[68:71], v[96:111]
    ds_read_b64_tr_b16 v[32:33], v9 offset:20480
    ds_read_b64_tr_b16 v[34:35], v9 offset:20992
    ds_read_b128 v[36:39], v7 offset:16384
    s_add_u32 m0, s68, 40960
    s_cmp_eq_u32 s50, 14
    buffer_load_dwordx4 v4, s[20:23], s70 offen  lds
    v_mfma_f32_32x32x16_bf16 v[96:111], v[72:75], v[76:79], v[96:111]
    ds_read_b64_tr_b16 v[40:41], v9 offset:22528
    ds_read_b64_tr_b16 v[42:43], v9 offset:23040
    ds_read_b128 v[44:47], v8 offset:16384
    s_cselect_b32 s50, 0, s50
    s_add_u32 s70, s70, 7168
    buffer_load_dwordx4 v4, s[20:23], s70 offen offset:1024  lds
    s_waitcnt vmcnt(8) lgkmcnt(0)
    s_barrier
    s_cmp_eq_u32 s52, 2
    s_cbranch_scc0 K_nl7
    s_mov_b32 s39, 0
K_fl8:
    v_cmp_ne_u32 vcc, s32, v12
    s_nop 0
    s_and_b64 vcc, vcc, s[58:59]
    s_cbranch_vccz K_fd9
    s_cmp_ge_u32 s39, 32768
    s_cbranch_scc1 K_fd9
    s_sleep 3
    buffer_load_dword v12, v10, s[24:27], s60 offen sc0 sc1
    s_add_u32 s39, s39, 1
    s_waitcnt vmcnt(0)
    s_branch K_fl8
K_fd9:
    s_mov_b32 s51, 1
K_nl7:
    v_mfma_f32_32x32x16_bf16 v[96:111], v[16:19], v[20:23], v[96:111]
    ds_read_b64_tr_b16 v[48:49], v9 offset:24576
    ds_read_b64_tr_b16 v[50:51], v9 offset:25088
    ds_read_b128 v[52:55], v5 offset:24576
    s_lshl_b32 s38, s50, 1
    s_add_u32 s38, s38, s51
    s_lshl_b32 s69, s38, 13
    s_add_u32 s69, s69, s53
    s_lshl_b32 s70, s38, 16
    s_add_u32 m0, s68, 16384
    s_nop 0
    buffer_load_dwordx4 v2, s[24:27], s69 offen sc1 lds
    v_mfma_f32_32x32x16_bf16 v[96:111], v[24:27], v[28:31], v[96:111]
    ds_read_b64_tr_b16 v[56:57], v9 offset:26624
    ds_read_b64_tr_b16 v[58:59], v9 offset:27136
    ds_read_b128 v[60:63], v6 offset:24576
    s_add_u32 s70, s70, s54
    s_add_u32 s50, s50, 1
    buffer_load_dwordx4 v3, s[24:27], s69 offen offset:1024 sc1 lds
    v_mfma_f32_32x32x16_bf16 v[96:111], v[32:35], v[36:39], v[96:111]
    ds_read_b64_tr_b16 v[64:65], v9 offset:28672
    ds_read_b64_tr_b16 v[66:67], v9 offset:29184
    ds_read_b128 v[68:71], v7 offset:24576
    s_add_u32 m0, s68, 49152
    s_cmp_eq_u32 s50, 14
    buffer_load_dwordx4 v4, s[20:23], s70 offen  lds
    v_mfma_f32_32x32x16_bf16 v[96:111], v[40:43], v[44:47], v[96:111]
    ds_read_b64_tr_b16 v[72:73], v9 offset:30720
    ds_read_b64_tr_b16 v[74:75], v9 offset:31232
    ds_read_b128 v[76:79], v8 offset:24576
    s_cselect_b32 s50, 0, s50
    s_add_u32 s70, s70, 7168
    buffer_load_dwordx4 v4, s[20:23], s70 offen offset:1024  lds
    s_waitcnt vmcnt(8) lgkmcnt(0)
    s_barrier
    s_cmp_eq_u32 s52, 1
    s_cbranch_scc0 K_il10
    s_lshr_b32 s43, s48, 1
    s_lshl_b32 s43, s43, 11
    v_lshlrev_b32 v10, 7, v1
    v_cmp_gt_u32 s[58:59], 14, v1
    v_mov_b32 v12, 0x7ff00000
    s_add_u32 s60, s43, 98304
    v_cndmask_b32_e64 v10, v12, v10, s[58:59]
    buffer_load_dword v12, v10, s[24:27], s60 offen sc0 sc1
K_il10:
    v_mfma_f32_32x32x16_bf16 v[96:111], v[48:51], v[52:55], v[96:111]
    ds_read_b64_tr_b16 v[16:17], v9 offset:0
    ds_read_b64_tr_b16 v[18:19], v9 offset:512
    ds_read_b128 v[20:23], v5 offset:0
    s_lshl_b32 s38, s50, 1
    s_add_u32 s38, s38, s51
    s_lshl_b32 s69, s38, 13
    s_add_u32 s69, s69, s53
    s_lshl_b32 s70, s38, 16
    s_add_u32 m0, s68, 24576
    s_nop 0
    buffer_load_dwordx4 v2, s[24:27], s69 offen sc1 lds
    v_mfma_f32_32x32x16_bf16 v[96:111], v[56:59], v[60:63], v[96:111]
    ds_read_b64_tr_b16 v[24:25], v9 offset:2048
    ds_read_b64_tr_b16 v[26:27], v9 offset:2560
    ds_read_b128 v[28:31], v6 offset:0
    s_add_u32 s70, s70, s54
    s_add_u32 s50, s50, 1
    buffer_load_dwordx4 v3, s[24:27], s69 offen offset:1024 sc1 lds
    v_mfma_f32_32x32x16_bf16 v[96:111], v[64:67], v[68:71], v[96:111]
    ds_read_b64_tr_b16 v[32:33], v9 offset:4096
    ds_read_b64_tr_b16 v[34:35], v9 offset:4608
    ds_read_b128 v[36:39], v7 offset:0
    s_add_u32 m0, s68, 57344
    s_cmp_eq_u32 s50, 14
    buffer_load_dwordx4 v4, s[20:23], s70 offen  lds
    v_mfma_f32_32x32x16_bf16 v[96:111], v[72:75], v[76:79], v[96:111]
    ds_read_b64_tr_b16 v[40:41], v9 offset:6144
    ds_read_b64_tr_b16 v[42:43], v9 offset:6656
    ds_read_b128 v[44:47], v8 offset:0
    s_cselect_b32 s50, 0, s50
    s_add_u32 s70, s70, 7168
    buffer_load_dwordx4 v4, s[20:23], s70 offen offset:1024  lds
    s_add_u32 s52, s52, 1
    s_cmp_lt_u32 s52, 6
    s_cbranch_scc1 K_g2loop
    s_waitcnt vmcnt(8) lgkmcnt(0)
    s_barrier
    s_mov_b32 s39, 0
K_fl11:
    v_cmp_ne_u32 vcc, s32, v11
    s_nop 0
    s_and_b64 vcc, vcc, s[62:63]
    s_cbranch_vccz K_fd12
    s_cmp_ge_u32 s39, 32768
    s_cbranch_scc1 K_fd12
    s_sleep 3
    buffer_load_dword v11, v13, s[24:27], s61 offen sc0 sc1
    s_add_u32 s39, s39, 1
    s_waitcnt vmcnt(0)
    s_branch K_fl11
K_fd12:
    s_lshr_b32 s38, s6, 1
    s_lshl_b32 s38, s38, 5
    s_lshl_b32 s39, s48, 6
    s_add_u32 s38, s38, s39
    v_and_b32 v14, 31, v1
    v_add_u32 v14, s38, v14
    v_lshlrev_b32 v15, 3, v14
    v_lshlrev_b32 v14, 10, v14
    v_lshrrev_b32 v93, 5, v1
    v_lshl_add_u32 v14, v93, 4, v14
    s_and_b32 s38, s6, 1
    s_lshl_b32 s38, s38, 6
    s_lshl_b32 s39, s49, 7
    s_add_u32 s38, s38, s39
    v_add_u32 v86, s38, v14
    s_mov_b32 s40, 131072
    buffer_load_dwordx2 v[88:89], v15, s[24:27], s40 offen sc1
    v_mfma_f32_32x32x16_bf16 v[96:111], v[16:19], v[20:23], v[96:111]
    ds_read_b64_tr_b16 v[48:49], v9 offset:8192
    ds_read_b64_tr_b16 v[50:51], v9 offset:8704
    ds_read_b128 v[52:55], v5 offset:8192
    s_add_u32 s69, s71, 0
    s_add_u32 m0, s68, 0
    s_nop 0
    buffer_load_dwordx4 v2, s[24:27], s69 offen sc1 lds
    v_mfma_f32_32x32x16_bf16 v[96:111], v[24:27], v[28:31], v[96:111]
    ds_read_b64_tr_b16 v[56:57], v9 offset:10240
    ds_read_b64_tr_b16 v[58:59], v9 offset:10752
    ds_read_b128 v[60:63], v6 offset:8192
    s_add_u32 s70, s72, 0
    buffer_load_dwordx4 v3, s[24:27], s69 offen offset:1024 sc1 lds
    v_mfma_f32_32x32x16_bf16 v[96:111], v[32:35], v[36:39], v[96:111]
    ds_read_b64_tr_b16 v[64:65], v9 offset:12288
    ds_read_b64_tr_b16 v[66:67], v9 offset:12800
    ds_read_b128 v[68:71], v7 offset:8192
    s_add_u32 m0, s68, 32768
    s_nop 0
    buffer_load_dwordx4 v85, s[24:27], s70 offen sc1 lds
    v_mfma_f32_32x32x16_bf16 v[96:111], v[40:43], v[44:47], v[96:111]
    ds_read_b64_tr_b16 v[72:73], v9 offset:14336
    ds_read_b64_tr_b16 v[74:75], v9 offset:14848
    ds_read_b128 v[76:79], v8 offset:8192
    s_add_u32 s70, s70, 32256
    buffer_load_dwordx4 v85, s[24:27], s70 offen offset:1024 sc1 lds
    s_waitcnt vmcnt(9) lgkmcnt(0)
    s_barrier
    v_mfma_f32_32x32x16_bf16 v[96:111], v[48:51], v[52:55], v[96:111]
    ds_read_b64_tr_b16 v[16:17], v9 offset:16384
    ds_read_b64_tr_b16 v[18:19], v9 offset:16896
    ds_read_b128 v[20:23], v5 offset:16384
    s_add_u32 s69, s71, 8192
    s_add_u32 m0, s68, 8192
    s_nop 0
    buffer_load_dwordx4 v2, s[24:27], s69 offen sc1 lds
    v_mfma_f32_32x32x16_bf16 v[96:111], v[56:59], v[60:63], v[96:111]
    ds_read_b64_tr_b16 v[24:25], v9 offset:18432
    ds_read_b64_tr_b16 v[26:27], v9 offset:18944
    ds_read_b128 v[28:31], v6 offset:16384
    s_add_u32 s70, s72, 266240
    buffer_load_dwordx4 v3, s[24:27], s69 offen offset:1024 sc1 lds
    v_mfma_f32_32x32x16_bf16 v[96:111], v[64:67], v[68:71], v[96:111]
    ds_read_b64_tr_b16 v[32:33], v9 offset:20480
    ds_read_b64_tr_b16 v[34:35], v9 offset:20992
    ds_read_b128 v[36:39], v7 offset:16384
    s_add_u32 m0, s68, 40960
    s_nop 0
    buffer_load_dwordx4 v85, s[24:27], s70 offen sc1 lds
    v_mfma_f32_32x32x16_bf16 v[96:111], v[72:75], v[76:79], v[96:111]
    ds_read_b64_tr_b16 v[40:41], v9 offset:22528
    ds_read_b64_tr_b16 v[42:43], v9 offset:23040
    ds_read_b128 v[44:47], v8 offset:16384
    s_add_u32 s70, s70, 32256
    buffer_load_dwordx4 v85, s[24:27], s70 offen offset:1024 sc1 lds
    s_waitcnt vmcnt(9) lgkmcnt(0)
    s_barrier
    v_mfma_f32_32x32x16_bf16 v[96:111], v[16:19], v[20:23], v[96:111]
    ds_read_b64_tr_b16 v[48:49], v9 offset:24576
    ds_read_b64_tr_b16 v[50:51], v9 offset:25088
    ds_read_b128 v[52:55], v5 offset:24576
    s_add_u32 s69, s71, 16384
    s_add_u32 m0, s68, 16384
    s_nop 0
    buffer_load_dwordx4 v2, s[24:27], s69 offen sc1 lds
    v_mfma_f32_32x32x16_bf16 v[96:111], v[24:27], v[28:31], v[96:111]
    ds_read_b64_tr_b16 v[56:57], v9 offset:26624
    ds_read_b64_tr_b16 v[58:59], v9 offset:27136
    ds_read_b128 v[60:63], v6 offset:24576
    s_add_u32 s70, s72, 532480
    buffer_load_dwordx4 v3, s[24:27], s69 offen offset:1024 sc1 lds
    v_mfma_f32_32x32x16_bf16 v[96:111], v[32:35], v[36:39], v[96:111]
    ds_read_b64_tr_b16 v[64:65], v9 offset:28672
    ds_read_b64_tr_b16 v[66:67], v9 offset:29184
    ds_read_b128 v[68:71], v7 offset:24576
    s_add_u32 m0, s68, 49152
    s_nop 0
    buffer_load_dwordx4 v85, s[24:27], s70 offen sc1 lds
    v_mfma_f32_32x32x16_bf16 v[96:111], v[40:43], v[44:47], v[96:111]
    ds_read_b64_tr_b16 v[72:73], v9 offset:30720
    ds_read_b64_tr_b16 v[74:75], v9 offset:31232
    ds_read_b128 v[76:79], v8 offset:24576
    s_add_u32 s70, s70, 32256
    buffer_load_dwordx4 v85, s[24:27], s70 offen offset:1024 sc1 lds
    s_waitcnt vmcnt(8) lgkmcnt(0)
    s_barrier
    v_mfma_f32_32x32x16_bf16 v[96:111], v[48:51], v[52:55], v[96:111]
    ds_read_b64_tr_b16 v[16:17], v84 offset:0
    ds_read_b64_tr_b16 v[18:19], v84 offset:512
    ds_read_b128 v[20:23], v80 offset:0
    s_add_u32 s69, s71, 24576
    s_add_u32 m0, s68, 24576
    s_nop 0
    buffer_load_dwordx4 v2, s[24:27], s69 offen sc1 lds
    v_mfma_f32_32x32x16_bf16 v[96:111], v[56:59], v[60:63], v[96:111]
    ds_read_b64_tr_b16 v[24:25], v84 offset:2048
    ds_read_b64_tr_b16 v[26:27], v84 offset:2560
    ds_read_b128 v[28:31], v81 offset:0
    s_add_u32 s70, s72, 798720
    buffer_load_dwordx4 v3, s[24:27], s69 offen offset:1024 sc1 lds
    v_mfma_f32_32x32x16_bf16 v[96:111], v[64:67], v[68:71], v[96:111]
    ds_read_b64_tr_b16 v[32:33], v84 offset:4096
    ds_read_b64_tr_b16 v[34:35], v84 offset:4608
    ds_read_b128 v[36:39], v82 offset:0
    s_add_u32 m0, s68, 57344
    s_nop 0
    buffer_load_dwordx4 v85, s[24:27], s70 offen sc1 lds
    v_mfma_f32_32x32x16_bf16 v[96:111], v[72:75], v[76:79], v[96:111]
    ds_read_b64_tr_b16 v[40:41], v84 offset:6144
    ds_read_b64_tr_b16 v[42:43], v84 offset:6656
    ds_read_b128 v[44:47], v83 offset:0
    s_add_u32 s70, s70, 32256
    buffer_load_dwordx4 v85, s[24:27], s70 offen offset:1024 sc1 lds
    s_waitcnt vmcnt(8) lgkmcnt(0)
    s_barrier
    v_mfma_f32_32x32x16_bf16 v[112:127], v[20:23], v[16:19], 0
    ds_read_b64_tr_b16 v[48:49], v84 offset:8192
    ds_read_b64_tr_b16 v[50:51], v84 offset:8704
    ds_read_b128 v[52:55], v80 offset:8192
    s_add_u32 s69, s71, 32768
    s_add_u32 m0, s68, 0
    s_nop 0
    buffer_load_dwordx4 v2, s[24:27], s69 offen sc1 lds
    v_mfma_f32_32x32x16_bf16 v[112:127], v[28:31], v[24:27], v[112:127]
    ds_read_b64_tr_b16 v[56:57], v84 offset:10240
    ds_read_b64_tr_b16 v[58:59], v84 offset:10752
    ds_read_b128 v[60:63], v81 offset:8192
    s_add_u32 s70, s72, 1064960
    buffer_load_dwordx4 v3, s[24:27], s69 offen offset:1024 sc1 lds
    v_mfma_f32_32x32x16_bf16 v[112:127], v[36:39], v[32:35], v[112:127]
    ds_read_b64_tr_b16 v[64:65], v84 offset:12288
    ds_read_b64_tr_b16 v[66:67], v84 offset:12800
    ds_read_b128 v[68:71], v82 offset:8192
    s_add_u32 m0, s68, 32768
    s_nop 0
    buffer_load_dwordx4 v85, s[24:27], s70 offen sc1 lds
    v_mfma_f32_32x32x16_bf16 v[112:127], v[44:47], v[40:43], v[112:127]
    ds_read_b64_tr_b16 v[72:73], v84 offset:14336
    ds_read_b64_tr_b16 v[74:75], v84 offset:14848
    ds_read_b128 v[76:79], v83 offset:8192
    s_add_u32 s70, s70, 32256
    buffer_load_dwordx4 v85, s[24:27], s70 offen offset:1024 sc1 lds
    s_waitcnt vmcnt(8) lgkmcnt(0)
    s_barrier
    v_mfma_f32_32x32x16_bf16 v[112:127], v[52:55], v[48:51], v[112:127]
    ds_read_b64_tr_b16 v[16:17], v84 offset:16384
    ds_read_b64_tr_b16 v[18:19], v84 offset:16896
    ds_read_b128 v[20:23], v80 offset:16384
    s_add_u32 s69, s71, 40960
    s_add_u32 m0, s68, 8192
    s_nop 0
    buffer_load_dwordx4 v2, s[24:27], s69 offen sc1 lds
    v_mfma_f32_32x32x16_bf16 v[112:127], v[60:63], v[56:59], v[112:127]
    ds_read_b64_tr_b16 v[24:25], v84 offset:18432
    ds_read_b64_tr_b16 v[26:27], v84 offset:18944
    ds_read_b128 v[28:31], v81 offset:16384
    s_add_u32 s70, s72, 1331200
    buffer_load_dwordx4 v3, s[24:27], s69 offen offset:1024 sc1 lds
    v_mfma_f32_32x32x16_bf16 v[112:127], v[68:71], v[64:67], v[112:127]
    ds_read_b64_tr_b16 v[32:33], v84 offset:20480
    ds_read_b64_tr_b16 v[34:35], v84 offset:20992
    ds_read_b128 v[36:39], v82 offset:16384
    s_add_u32 m0, s68, 40960
    s_nop 0
    buffer_load_dwordx4 v85, s[24:27], s70 offen sc1 lds
    v_mfma_f32_32x32x16_bf16 v[112:127], v[76:79], v[72:75], v[112:127]
    ds_read_b64_tr_b16 v[40:41], v84 offset:22528
    ds_read_b64_tr_b16 v[42:43], v84 offset:23040
    ds_read_b128 v[44:47], v83 offset:16384
    s_add_u32 s70, s70, 32256
    buffer_load_dwordx4 v85, s[24:27], s70 offen offset:1024 sc1 lds
    s_waitcnt vmcnt(8) lgkmcnt(0)
    s_barrier
    v_mfma_f32_32x32x16_bf16 v[112:127], v[20:23], v[16:19], v[112:127]
    ds_read_b64_tr_b16 v[48:49], v84 offset:24576
    ds_read_b64_tr_b16 v[50:51], v84 offset:25088
    ds_read_b128 v[52:55], v80 offset:24576
    s_add_u32 s69, s71, 49152
    s_add_u32 m0, s68, 16384
    s_nop 0
    buffer_load_dwordx4 v2, s[24:27], s69 offen sc1 lds
    v_mfma_f32_32x32x16_bf16 v[112:127], v[28:31], v[24:27], v[112:127]
    ds_read_b64_tr_b16 v[56:57], v84 offset:26624
    ds_read_b64_tr_b16 v[58:59], v84 offset:27136
    ds_read_b128 v[60:63], v81 offset:24576
    s_add_u32 s70, s72, 1597440
    buffer_load_dwordx4 v3, s[24:27], s69 offen offset:1024 sc1 lds
    v_mfma_f32_32x32x16_bf16 v[112:127], v[36:39], v[32:35], v[112:127]
    ds_read_b64_tr_b16 v[64:65], v84 offset:28672
    ds_read_b64_tr_b16 v[66:67], v84 offset:29184
    ds_read_b128 v[68:71], v82 offset:24576
    s_add_u32 m0, s68, 49152
    s_nop 0
    buffer_load_dwordx4 v85, s[24:27], s70 offen sc1 lds
    v_mfma_f32_32x32x16_bf16 v[112:127], v[44:47], v[40:43], v[112:127]
    ds_read_b64_tr_b16 v[72:73], v84 offset:30720
    ds_read_b64_tr_b16 v[74:75], v84 offset:31232
    ds_read_b128 v[76:79], v83 offset:24576
    s_add_u32 s70, s70, 32256
    buffer_load_dwordx4 v85, s[24:27], s70 offen offset:1024 sc1 lds
    s_waitcnt vmcnt(8) lgkmcnt(0)
    s_barrier
    v_mfma_f32_32x32x16_bf16 v[112:127], v[52:55], v[48:51], v[112:127]
    ds_read_b64_tr_b16 v[16:17], v84 offset:0
    ds_read_b64_tr_b16 v[18:19], v84 offset:512
    ds_read_b128 v[20:23], v80 offset:0
    s_add_u32 s69, s71, 57344
    s_add_u32 m0, s68, 24576
    s_nop 0
    buffer_load_dwordx4 v2, s[24:27], s69 offen sc1 lds
    v_mfma_f32_32x32x16_bf16 v[112:127], v[60:63], v[56:59], v[112:127]
    ds_read_b64_tr_b16 v[24:25], v84 offset:2048
    ds_read_b64_tr_b16 v[26:27], v84 offset:2560
    ds_read_b128 v[28:31], v81 offset:0
    s_add_u32 s70, s72, 1863680
    buffer_load_dwordx4 v3, s[24:27], s69 offen offset:1024 sc1 lds
    v_mfma_f32_32x32x16_bf16 v[112:127], v[68:71], v[64:67], v[112:127]
    ds_read_b64_tr_b16 v[32:33], v84 offset:4096
    ds_read_b64_tr_b16 v[34:35], v84 offset:4608
    ds_read_b128 v[36:39], v82 offset:0
    s_add_u32 m0, s68, 57344
    s_nop 0
    buffer_load_dwordx4 v85, s[24:27], s70 offen sc1 lds
    v_mfma_f32_32x32x16_bf16 v[112:127], v[76:79], v[72:75], v[112:127]
    ds_read_b64_tr_b16 v[40:41], v84 offset:6144
    ds_read_b64_tr_b16 v[42:43], v84 offset:6656
    ds_read_b128 v[44:47], v83 offset:0
    s_add_u32 s70, s70, 32256
    buffer_load_dwordx4 v85, s[24:27], s70 offen offset:1024 sc1 lds
    s_waitcnt vmcnt(8) lgkmcnt(0)
    s_barrier
    v_mfma_f32_32x32x16_bf16 v[112:127], v[20:23], v[16:19], v[112:127]
    ds_read_b64_tr_b16 v[48:49], v84 offset:8192
    ds_read_b64_tr_b16 v[50:51], v84 offset:8704
    ds_read_b128 v[52:55], v80 offset:8192
    v_mfma_f32_32x32x16_bf16 v[112:127], v[28:31], v[24:27], v[112:127]
    ds_read_b64_tr_b16 v[56:57], v84 offset:10240
    ds_read_b64_tr_b16 v[58:59], v84 offset:10752
    ds_read_b128 v[60:63], v81 offset:8192
    v_mfma_f32_32x32x16_bf16 v[112:127], v[36:39], v[32:35], v[112:127]
    ds_read_b64_tr_b16 v[64:65], v84 offset:12288
    ds_read_b64_tr_b16 v[66:67], v84 offset:12800
    ds_read_b128 v[68:71], v82 offset:8192
    v_mfma_f32_32x32x16_bf16 v[112:127], v[44:47], v[40:43], v[112:127]
    ds_read_b64_tr_b16 v[72:73], v84 offset:14336
    ds_read_b64_tr_b16 v[74:75], v84 offset:14848
    ds_read_b128 v[76:79], v83 offset:8192
    s_waitcnt vmcnt(4) lgkmcnt(0)
    s_barrier
    v_mfma_f32_32x32x16_bf16 v[112:127], v[52:55], v[48:51], v[112:127]
    ds_read_b64_tr_b16 v[16:17], v84 offset:16384
    ds_read_b64_tr_b16 v[18:19], v84 offset:16896
    ds_read_b128 v[20:23], v80 offset:16384
    v_mfma_f32_32x32x16_bf16 v[112:127], v[60:63], v[56:59], v[112:127]
    ds_read_b64_tr_b16 v[24:25], v84 offset:18432
    ds_read_b64_tr_b16 v[26:27], v84 offset:18944
    ds_read_b128 v[28:31], v81 offset:16384
    v_mfma_f32_32x32x16_bf16 v[112:127], v[68:71], v[64:67], v[112:127]
    ds_read_b64_tr_b16 v[32:33], v84 offset:20480
    ds_read_b64_tr_b16 v[34:35], v84 offset:20992
    ds_read_b128 v[36:39], v82 offset:16384
    v_mfma_f32_32x32x16_bf16 v[112:127], v[76:79], v[72:75], v[112:127]
    ds_read_b64_tr_b16 v[40:41], v84 offset:22528
    ds_read_b64_tr_b16 v[42:43], v84 offset:23040
    ds_read_b128 v[44:47], v83 offset:16384
    s_waitcnt vmcnt(0) lgkmcnt(0)
    s_barrier
    v_mfma_f32_32x32x16_bf16 v[112:127], v[20:23], v[16:19], v[112:127]
    ds_read_b64_tr_b16 v[48:49], v84 offset:24576
    ds_read_b64_tr_b16 v[50:51], v84 offset:25088
    ds_read_b128 v[52:55], v80 offset:24576
    v_mfma_f32_32x32x16_bf16 v[112:127], v[28:31], v[24:27], v[112:127]
    ds_read_b64_tr_b16 v[56:57], v84 offset:26624
    ds_read_b64_tr_b16 v[58:59], v84 offset:27136
    ds_read_b128 v[60:63], v81 offset:24576
    v_mfma_f32_32x32x16_bf16 v[112:127], v[36:39], v[32:35], v[112:127]
    ds_read_b64_tr_b16 v[64:65], v84 offset:28672
    ds_read_b64_tr_b16 v[66:67], v84 offset:29184
    ds_read_b128 v[68:71], v82 offset:24576
    v_mfma_f32_32x32x16_bf16 v[112:127], v[44:47], v[40:43], v[112:127]
    ds_read_b64_tr_b16 v[72:73], v84 offset:30720
    ds_read_b64_tr_b16 v[74:75], v84 offset:31232
    ds_read_b128 v[76:79], v83 offset:24576
    s_waitcnt vmcnt(0) lgkmcnt(0)
    s_barrier
    v_mfma_f32_32x32x16_bf16 v[112:127], v[52:55], v[48:51], v[112:127]
    v_mfma_f32_32x32x16_bf16 v[112:127], v[60:63], v[56:59], v[112:127]
    v_mfma_f32_32x32x16_bf16 v[112:127], v[68:71], v[64:67], v[112:127]
    v_mfma_f32_32x32x16_bf16 v[112:127], v[76:79], v[72:75], v[112:127]
    v_pk_mul_f32 v[96:97], v[96:97], v[88:89] op_sel:[0,1] op_sel_hi:[1,1]
    v_pk_mul_f32 v[98:99], v[98:99], v[88:89] op_sel:[0,1] op_sel_hi:[1,1]
    v_pk_mul_f32 v[100:101], v[100:101], v[88:89] op_sel:[0,1] op_sel_hi:[1,1]
    v_pk_mul_f32 v[102:103], v[102:103], v[88:89] op_sel:[0,1] op_sel_hi:[1,1]
    v_pk_mul_f32 v[104:105], v[104:105], v[88:89] op_sel:[0,1] op_sel_hi:[1,1]
    v_pk_mul_f32 v[106:107], v[106:107], v[88:89] op_sel:[0,1] op_sel_hi:[1,1]
    v_pk_mul_f32 v[108:109], v[108:109], v[88:89] op_sel:[0,1] op_sel_hi:[1,1]
    v_pk_mul_f32 v[110:111], v[110:111], v[88:89] op_sel:[0,1] op_sel_hi:[1,1]
    s_nop 3
    v_pk_fma_f32 v[96:97], v[112:113], v[88:89], v[96:97] op_sel_hi:[1,0,1]
    v_pk_fma_f32 v[98:99], v[114:115], v[88:89], v[98:99] op_sel_hi:[1,0,1]
    v_pk_fma_f32 v[100:101], v[116:117], v[88:89], v[100:101] op_sel_hi:[1,0,1]
    v_pk_fma_f32 v[102:103], v[118:119], v[88:89], v[102:103] op_sel_hi:[1,0,1]
    v_pk_fma_f32 v[104:105], v[120:121], v[88:89], v[104:105] op_sel_hi:[1,0,1]
    v_pk_fma_f32 v[106:107], v[122:123], v[88:89], v[106:107] op_sel_hi:[1,0,1]
    v_pk_fma_f32 v[108:109], v[124:125], v[88:89], v[108:109] op_sel_hi:[1,0,1]
    v_pk_fma_f32 v[110:111], v[126:127], v[88:89], v[110:111] op_sel_hi:[1,0,1]
    v_permlane32_swap_b32 v96, v100
    v_permlane32_swap_b32 v97, v101
    v_permlane32_swap_b32 v98, v102
    v_permlane32_swap_b32 v99, v103
    v_permlane32_swap_b32 v104, v108
    v_permlane32_swap_b32 v105, v109
    v_permlane32_swap_b32 v106, v110
    v_permlane32_swap_b32 v107, v111
    v_cvt_pk_bf16_f32 v24, v96, v97
    v_cvt_pk_bf16_f32 v25, v98, v99
    v_cvt_pk_bf16_f32 v26, v100, v101
    v_cvt_pk_bf16_f32 v27, v102, v103
    buffer_store_dwordx4 v[24:27], v86, s[28:31], 0 offen offset:0
    v_cvt_pk_bf16_f32 v28, v104, v105
    v_cvt_pk_bf16_f32 v29, v106, v107
    v_cvt_pk_bf16_f32 v30, v108, v109
    v_cvt_pk_bf16_f32 v31, v110, v111
    buffer_store_dwordx4 v[28:31], v86, s[28:31], 0 offen offset:32
    s_endpgm
K_roleF:
    v_lshrrev_b32 v4, 6, v0
    s_lshr_b32 s29, s2, 3
    s_and_b32 s29, s29, 31
    v_readfirstlane_b32 s30, v4
    s_nop 0
    s_cmp_lg_u32 s30, 3
    s_cbranch_scc1 K_cp13
    s_cmp_ge_u32 s29, (K_end-gated_mix__spectral_gfnet__dense_activation_mish__prompt_kernel)>>10
    s_cbranch_scc1 K_cp13
    s_getpc_b64 s[62:63]
K_pc:
    s_sub_u32 s62, s62, K_pc-gated_mix__spectral_gfnet__dense_activation_mish__prompt_kernel
    s_subb_u32 s63, s63, 0
    s_lshl_b32 s29, s29, 10
    v_and_b32 v4, 63, v0
    v_lshlrev_b32 v4, 7, v4
    v_add_u32 v4, s29, v4
    v_mov_b32 v5, s63
    v_add_co_u32 v4, vcc, s62, v4
    s_nop 1
    v_addc_co_u32 v5, vcc, 0, v5, vcc
    s_mov_b64 s[48:49], exec
    s_mov_b64 exec, 0xff
    global_load_dword v238, v[4:5], off
    s_mov_b64 exec, s[48:49]
K_cp13:
    s_load_dwordx4 s[32:35], s[0:1], 0
    s_load_dwordx2 s[36:37], s[0:1], 16
    s_load_dwordx2 s[38:39], s[0:1], 56
    s_load_dwordx2 s[40:41], s[0:1], 80
    s_load_dwordx2 s[60:61], s[0:1], 48
    s_and_b32 s3, s2, 255
    s_and_b32 s4, s3, 7
    s_lshr_b32 s5, s3, 3
    v_lshrrev_b32 v4, 6, v0
    v_and_b32 v1, 63, v0
    v_readfirstlane_b32 s6, v4
    v_and_b32 v2, 15, v1
    v_lshrrev_b32 v3, 4, v1
    s_waitcnt lgkmcnt(0)
    s_mov_b32 s8, s32
    s_and_b32 s9, s33, 0xffff
    s_mov_b32 s10, 2097152
    s_mov_b32 s11, 131072
    s_mov_b32 s12, s34
    s_and_b32 s13, s35, 0xffff
    s_mov_b32 s14, 1052672
    s_mov_b32 s15, 131072
    s_mov_b32 s16, s36
    s_and_b32 s17, s37, 0xffff
    s_mov_b32 s18, 1052672
    s_mov_b32 s19, 131072
    s_mov_b32 s20, s38
    s_and_b32 s21, s39, 0xffff
    s_mov_b32 s22, 1024
    s_mov_b32 s23, 131072
    s_mov_b32 s24, s40
    s_and_b32 s25, s41, 0xffff
    s_mov_b32 s26, 268435456
    s_mov_b32 s27, 131072
    s_mov_b32 s56, s60
    s_and_b32 s57, s61, 0xffff
    s_mov_b32 s58, 1835008
    s_mov_b32 s59, 131072
    s_load_dword s28, s[40:41], 0
    v_lshlrev_b32 v96, 4, v1
    s_lshl_b32 s29, s4, 8
    s_add_u32 s29, s29, s5
    s_lshl_b32 s30, s6, 6
    s_add_u32 s29, s29, s30
    s_lshl_b32 s29, s29, 10
    s_mul_i32 s30, s6, 2176
    s_add_u32 m0, s30, 0
    s_add_u32 s31, s29, 32768
    buffer_load_dwordx4 v96, s[8:11], s29 offen lds
    s_add_u32 m0, m0, 1088
    v_and_b32 v97, 31, v0
    buffer_load_dwordx4 v96, s[8:11], s31 offen lds
    v_lshlrev_b32 v97, 5, v97
    buffer_load_dwordx4 v[206:209], v97, s[20:23], 0 offen
    buffer_load_dwordx4 v[210:213], v97, s[20:23], 0 offen offset:16
    s_lshl_b32 s29, s6, 4
    v_add_u32 v4, s29, v2
    v_cvt_f32_u32 v4, v4
    v_mul_f32 v4, 0x3c800000, v4
    v_lshlrev_b32 v5, 3, v3
    v_cvt_f32_u32 v5, v5
    v_mul_f32 v8, v5, v4
    v_and_b32 v6, 1, v2
    v_mul_u32_u24 v6, 0x8000, v6
    v_lshl_or_b32 v239, v6, 16, v6
    v_add_f32 v9, v8, v4
    v_add_f32 v10, v9, v4
    v_add_f32 v11, v10, v4
    v_add_f32 v12, v11, v4
    v_add_f32 v13, v12, v4
    v_add_f32 v14, v13, v4
    v_add_f32 v15, v14, v4
    v_cos_f32 v16, v8
    v_sin_f32 v24, v8
    v_cos_f32 v17, v9
    v_sin_f32 v25, v9
    v_cos_f32 v18, v10
    v_sin_f32 v26, v10
    v_cos_f32 v19, v11
    v_sin_f32 v27, v11
    v_cos_f32 v20, v12
    v_sin_f32 v28, v12
    v_cos_f32 v21, v13
    v_sin_f32 v29, v13
    v_cos_f32 v22, v14
    v_sin_f32 v30, v14
    v_cos_f32 v23, v15
    v_sin_f32 v31, v15
    v_cvt_pk_bf16_f32 v100, v16, v17
    v_cvt_pk_bf16_f32 v108, v24, v25
    v_cvt_pk_bf16_f32 v116, -v24, -v25
    v_cvt_pk_bf16_f32 v101, v18, v19
    v_cvt_pk_bf16_f32 v109, v26, v27
    v_cvt_pk_bf16_f32 v117, -v26, -v27
    v_cvt_pk_bf16_f32 v102, v20, v21
    v_cvt_pk_bf16_f32 v110, v28, v29
    v_cvt_pk_bf16_f32 v118, -v28, -v29
    v_cvt_pk_bf16_f32 v103, v22, v23
    v_cvt_pk_bf16_f32 v111, v30, v31
    v_cvt_pk_bf16_f32 v119, -v30, -v31
    v_xor_b32 v104, v239, v100
    v_xor_b32 v112, v239, v108
    v_xor_b32 v120, v239, v116
    v_xor_b32 v105, v239, v101
    v_xor_b32 v113, v239, v109
    v_xor_b32 v121, v239, v117
    v_xor_b32 v106, v239, v102
    v_xor_b32 v114, v239, v110
    v_xor_b32 v122, v239, v118
    v_xor_b32 v107, v239, v103
    v_xor_b32 v115, v239, v111
    v_xor_b32 v123, v239, v119
    v_and_b32 v6, 1, v3
    v_lshlrev_b32 v6, 2, v6
    v_cvt_f32_u32 v6, v6
    v_mul_f32 v7, 0x3e000000, v4
    v_mul_f32 v8, v6, v7
    v_add_f32 v9, v8, v7
    v_add_f32 v10, v9, v7
    v_add_f32 v11, v10, v7
    v_cos_f32 v180, v8
    v_sin_f32 v184, v8
    v_cos_f32 v181, v9
    v_sin_f32 v185, v9
    v_cos_f32 v182, v10
    v_sin_f32 v186, v10
    v_cos_f32 v183, v11
    v_sin_f32 v187, v11
    v_lshrrev_b32 v7, 2, v2
    v_cvt_f32_u32 v7, v7
    v_mul_f32 v7, 0x3e000000, v7
    v_mul_f32 v8, v6, v7
    v_add_f32 v9, v8, v7
    v_add_f32 v10, v9, v7
    v_add_f32 v11, v10, v7
    v_cos_f32 v16, v8
    v_sin_f32 v20, v8
    v_cos_f32 v17, v9
    v_sin_f32 v21, v9
    v_cos_f32 v18, v10
    v_sin_f32 v22, v10
    v_cos_f32 v19, v11
    v_sin_f32 v23, v11
    v_and_b32 v12, 1, v2
    v_lshrrev_b32 v13, 1, v3
    v_cmp_eq_u32 s[48:49], v12, v13
    v_and_b32 v12, 2, v2
    v_cmp_ne_u32 vcc, 0, v12
    s_nop 1
    v_cndmask_b32_e64 v24, v16, -v20, vcc
    v_cndmask_b32_e64 v28, v20, v16, vcc
    v_cndmask_b32_e64 v25, v17, -v21, vcc
    v_cndmask_b32_e64 v29, v21, v17, vcc
    v_cndmask_b32_e64 v26, v18, -v22, vcc
    v_cndmask_b32_e64 v30, v22, v18, vcc
    v_cndmask_b32_e64 v27, v19, -v23, vcc
    v_cndmask_b32_e64 v31, v23, v19, vcc
    v_cndmask_b32_e64 v24, 0, v24, s[48:49]
    v_cndmask_b32_e64 v25, 0, v25, s[48:49]
    v_cndmask_b32_e64 v26, 0, v26, s[48:49]
    v_cndmask_b32_e64 v27, 0, v27, s[48:49]
    v_cndmask_b32_e64 v28, 0, v28, s[48:49]
    v_cndmask_b32_e64 v29, 0, v29, s[48:49]
    v_cndmask_b32_e64 v30, 0, v30, s[48:49]
    v_cndmask_b32_e64 v31, 0, v31, s[48:49]
    v_cvt_pk_bf16_f32 v164, v24, v25
    v_cvt_pk_bf16_f32 v165, v26, v27
    v_cvt_pk_bf16_f32 v166, v28, v29
    v_cvt_pk_bf16_f32 v167, v30, v31
    v_cmp_gt_u32 s[50:51], 4, v2
    v_mov_b32 v12, 0x3f003f00
    v_mov_b32 v13, 0xbf003f00
    s_and_b64 s[48:49], s[48:49], s[50:51]
    v_cndmask_b32 v12, v12, v13, vcc
    v_mov_b32 v170, 0
    v_mov_b32 v171, 0
    v_cndmask_b32_e64 v168, 0, v12, s[48:49]
    v_mov_b32 v169, v168
    s_waitcnt lgkmcnt(0)
    s_add_u32 s28, s28, 1
    v_bfe_u32 v4, v2, 1, 1
    v_mul_u32_u24 v4, 1088, v4
    v_lshl_add_u32 v4, v3, 7, v4
    v_lshrrev_b32 v5, 2, v2
    v_lshl_add_u32 v4, v5, 4, v4
    v_and_b32 v5, 1, v2
    v_lshl_add_u32 v4, v5, 3, v4
    v_lshrrev_b32 v5, 5, v0
    v_mul_u32_u24 v5, 1088, v5
    v_and_b32 v6, 31, v0
    v_lshl_add_u32 v5, v6, 5, v5
    s_waitcnt vmcnt(0)
    s_barrier
    ds_read_b64_tr_b16 v[8:9], v4 offset:0
    ds_read_b64_tr_b16 v[10:11], v4 offset:64
    ds_read_b64_tr_b16 v[12:13], v4 offset:512
    ds_read_b64_tr_b16 v[14:15], v4 offset:576
    ds_read_b64_tr_b16 v[16:17], v4 offset:2176
    ds_read_b64_tr_b16 v[18:19], v4 offset:2240
    ds_read_b64_tr_b16 v[20:21], v4 offset:2688
    ds_read_b64_tr_b16 v[22:23], v4 offset:2752
    ds_read_b64_tr_b16 v[24:25], v4 offset:4352
    ds_read_b64_tr_b16 v[26:27], v4 offset:4416
    ds_read_b64_tr_b16 v[28:29], v4 offset:4864
    ds_read_b64_tr_b16 v[30:31], v4 offset:4928
    ds_read_b64_tr_b16 v[32:33], v4 offset:6528
    ds_read_b64_tr_b16 v[34:35], v4 offset:6592
    ds_read_b64_tr_b16 v[36:37], v4 offset:7040
    ds_read_b64_tr_b16 v[38:39], v4 offset:7104
    ds_read_b128 v[214:217], v5 offset:0
    ds_read_b128 v[218:221], v5 offset:16
    s_waitcnt lgkmcnt(14)
    v_mfma_f32_16x16x32_bf16 v[40:43], v[8:11], v[100:103], 0
    v_mfma_f32_16x16x32_bf16 v[44:47], v[8:11], v[116:119], 0
    v_mfma_f32_16x16x32_bf16 v[40:43], v[12:15], v[104:107], v[40:43]
    v_mfma_f32_16x16x32_bf16 v[44:47], v[12:15], v[120:123], v[44:47]
    s_waitcnt lgkmcnt(10)
    v_mfma_f32_16x16x32_bf16 v[48:51], v[16:19], v[100:103], 0
    v_mfma_f32_16x16x32_bf16 v[52:55], v[16:19], v[116:119], 0
    v_mfma_f32_16x16x32_bf16 v[48:51], v[20:23], v[104:107], v[48:51]
    v_mfma_f32_16x16x32_bf16 v[52:55], v[20:23], v[120:123], v[52:55]
    s_waitcnt lgkmcnt(6)
    v_mfma_f32_16x16x32_bf16 v[56:59], v[24:27], v[100:103], 0
    v_mfma_f32_16x16x32_bf16 v[60:63], v[24:27], v[116:119], 0
    v_mfma_f32_16x16x32_bf16 v[56:59], v[28:31], v[104:107], v[56:59]
    v_mfma_f32_16x16x32_bf16 v[60:63], v[28:31], v[120:123], v[60:63]
    s_waitcnt lgkmcnt(2)
    v_mfma_f32_16x16x32_bf16 v[64:67], v[32:35], v[100:103], 0
    v_mfma_f32_16x16x32_bf16 v[68:71], v[32:35], v[116:119], 0
    v_mfma_f32_16x16x32_bf16 v[64:67], v[36:39], v[104:107], v[64:67]
    v_mfma_f32_16x16x32_bf16 v[68:71], v[36:39], v[120:123], v[68:71]
    s_lshl_b32 s29, s6, 2
    v_lshrrev_b32 v6, 2, v2
    v_add_u32 v6, s29, v6
    v_lshl_add_u32 v6, v3, 4, v6
    v_lshlrev_b32 v6, 7, v6
    v_and_b32 v7, 3, v2
    v_lshl_add_u32 v6, v7, 4, v6
    s_mul_i32 s30, s3, 8320
    s_add_u32 s30, s30, 1048576
    v_pk_mul_f32 v[8:9], v[40:41], v[180:181]
    v_pk_mul_f32 v[10:11], v[44:45], v[180:181]
    v_pk_fma_f32 v[12:13], v[44:45], v[184:185], v[8:9]
    v_pk_fma_f32 v[16:17], v[40:41], v[184:185], v[10:11] neg_lo:[1,0,0] neg_hi:[1,0,0]
    v_pk_mul_f32 v[8:9], v[42:43], v[182:183]
    v_pk_mul_f32 v[10:11], v[46:47], v[182:183]
    v_pk_fma_f32 v[14:15], v[46:47], v[186:187], v[8:9]
    v_pk_fma_f32 v[18:19], v[42:43], v[186:187], v[10:11] neg_lo:[1,0,0] neg_hi:[1,0,0]
    v_cvt_pk_bf16_f32 v72, v12, v13
    v_cvt_pk_bf16_f32 v73, v14, v15
    v_cvt_pk_bf16_f32 v74, v16, v17
    v_cvt_pk_bf16_f32 v75, v18, v19
    s_nop 1
    v_mfma_f32_16x16x32_bf16 v[80:83], v[164:167], v[72:75], 0
    v_mfma_f32_16x16x32_bf16 v[124:127], v[168:171], v[72:75], 0
    v_pk_mul_f32 v[8:9], v[48:49], v[180:181]
    v_pk_mul_f32 v[10:11], v[52:53], v[180:181]
    v_pk_fma_f32 v[12:13], v[52:53], v[184:185], v[8:9]
    v_pk_fma_f32 v[16:17], v[48:49], v[184:185], v[10:11] neg_lo:[1,0,0] neg_hi:[1,0,0]
    v_pk_mul_f32 v[8:9], v[50:51], v[182:183]
    v_pk_mul_f32 v[10:11], v[54:55], v[182:183]
    v_pk_fma_f32 v[14:15], v[54:55], v[186:187], v[8:9]
    v_pk_fma_f32 v[18:19], v[50:51], v[186:187], v[10:11] neg_lo:[1,0,0] neg_hi:[1,0,0]
    v_cvt_pk_bf16_f32 v76, v12, v13
    v_cvt_pk_bf16_f32 v77, v14, v15
    v_cvt_pk_bf16_f32 v78, v16, v17
    v_cvt_pk_bf16_f32 v79, v18, v19
    s_nop 1
    v_mfma_f32_16x16x32_bf16 v[84:87], v[164:167], v[76:79], 0
    v_mfma_f32_16x16x32_bf16 v[128:131], v[168:171], v[76:79], 0
    v_pk_mul_f32 v[8:9], v[56:57], v[180:181]
    v_pk_mul_f32 v[10:11], v[60:61], v[180:181]
    v_pk_fma_f32 v[12:13], v[60:61], v[184:185], v[8:9]
    v_pk_fma_f32 v[16:17], v[56:57], v[184:185], v[10:11] neg_lo:[1,0,0] neg_hi:[1,0,0]
    v_pk_mul_f32 v[8:9], v[58:59], v[182:183]
    v_pk_mul_f32 v[10:11], v[62:63], v[182:183]
    v_pk_fma_f32 v[14:15], v[62:63], v[186:187], v[8:9]
    v_pk_fma_f32 v[18:19], v[58:59], v[186:187], v[10:11] neg_lo:[1,0,0] neg_hi:[1,0,0]
    v_cvt_pk_bf16_f32 v72, v12, v13
    v_cvt_pk_bf16_f32 v73, v14, v15
    v_cvt_pk_bf16_f32 v74, v16, v17
    v_cvt_pk_bf16_f32 v75, v18, v19
    s_nop 1
    v_mfma_f32_16x16x32_bf16 v[88:91], v[164:167], v[72:75], 0
    v_mfma_f32_16x16x32_bf16 v[132:135], v[168:171], v[72:75], 0
    v_pk_mul_f32 v[8:9], v[64:65], v[180:181]
    v_pk_mul_f32 v[10:11], v[68:69], v[180:181]
    v_pk_fma_f32 v[12:13], v[68:69], v[184:185], v[8:9]
    v_pk_fma_f32 v[16:17], v[64:65], v[184:185], v[10:11] neg_lo:[1,0,0] neg_hi:[1,0,0]
    v_pk_mul_f32 v[8:9], v[66:67], v[182:183]
    v_pk_mul_f32 v[10:11], v[70:71], v[182:183]
    v_pk_fma_f32 v[14:15], v[70:71], v[186:187], v[8:9]
    v_pk_fma_f32 v[18:19], v[66:67], v[186:187], v[10:11] neg_lo:[1,0,0] neg_hi:[1,0,0]
    v_cvt_pk_bf16_f32 v76, v12, v13
    v_cvt_pk_bf16_f32 v77, v14, v15
    v_cvt_pk_bf16_f32 v78, v16, v17
    v_cvt_pk_bf16_f32 v79, v18, v19
    s_nop 1
    v_mfma_f32_16x16x32_bf16 v[92:95], v[164:167], v[76:79], 0
    v_mfma_f32_16x16x32_bf16 v[136:139], v[168:171], v[76:79], 0
    v_cvt_pk_bf16_f32 v20, v80, v81
    v_cvt_pk_bf16_f32 v24, v82, v83
    v_cvt_pk_bf16_f32 v21, v84, v85
    v_cvt_pk_bf16_f32 v25, v86, v87
    v_cvt_pk_bf16_f32 v22, v88, v89
    v_cvt_pk_bf16_f32 v26, v90, v91
    s_nop 0
    v_cvt_pk_bf16_f32 v23, v92, v93
    v_cvt_pk_bf16_f32 v27, v94, v95
    v_cvt_pk_bf16_f32 v28, v124, v125
    v_cvt_pk_bf16_f32 v32, v126, v127
    v_cvt_pk_bf16_f32 v29, v128, v129
    v_cvt_pk_bf16_f32 v33, v130, v131
    v_cvt_pk_bf16_f32 v30, v132, v133
    v_cvt_pk_bf16_f32 v34, v134, v135
    v_cvt_pk_bf16_f32 v31, v136, v137
    v_cvt_pk_bf16_f32 v35, v138, v139
    s_cmp_eq_u32 s6, 0
    s_cselect_b32 s29, 1, 0
    v_cmp_gt_u32 vcc, s29, v1
    s_nop 1
    v_cndmask_b32 v20, v20, v28, vcc
    v_cndmask_b32 v21, v21, v29, vcc
    v_cndmask_b32 v22, v22, v30, vcc
    v_cndmask_b32 v23, v23, v31, vcc
    v_cndmask_b32 v24, v24, v32, vcc
    v_cndmask_b32 v25, v25, v33, vcc
    v_cndmask_b32 v26, v26, v34, vcc
    v_cndmask_b32 v27, v27, v35, vcc
    buffer_store_dwordx4 v[20:23], v6, s[24:27], s30 offen sc1
    buffer_store_dwordx4 v[24:27], v6, s[24:27], s30 offen offset:64 sc1
    s_waitcnt vmcnt(0)
    s_barrier
    s_cmp_eq_u32 s6, 0
    s_cselect_b32 s30, 0, 0x7ff00000
    s_lshl_b32 s29, s3, 2
    s_add_u32 s29, s29, 4096
    v_mov_b32 v14, s28
    v_mov_b32 v15, s30
    s_mov_b64 s[48:49], exec
    s_mov_b64 exec, 1
    buffer_store_dword v14, v15, s[24:27], s29 offen sc0 sc1
    s_mov_b64 exec, s[48:49]
    s_waitcnt lgkmcnt(0)
    s_mov_b32 s31, 0x3f803f80
    v_lshlrev_b32 v8, 16, v214
    v_and_b32 v9, 0xffff0000, v214
    v_lshlrev_b32 v10, 16, v206
    v_and_b32 v11, 0xffff0000, v206
    v_pk_mul_f32 v[8:9], v[8:9], v[10:11]
    v_cvt_pk_bf16_f32 v214, v8, v9
    v_lshlrev_b32 v12, 16, v215
    v_and_b32 v13, 0xffff0000, v215
    v_lshlrev_b32 v14, 16, v207
    v_and_b32 v15, 0xffff0000, v207
    v_pk_mul_f32 v[12:13], v[12:13], v[14:15]
    v_cvt_pk_bf16_f32 v215, v12, v13
    v_lshlrev_b32 v16, 16, v216
    v_and_b32 v17, 0xffff0000, v216
    v_lshlrev_b32 v18, 16, v208
    v_and_b32 v19, 0xffff0000, v208
    v_pk_mul_f32 v[16:17], v[16:17], v[18:19]
    v_cvt_pk_bf16_f32 v216, v16, v17
    v_lshlrev_b32 v20, 16, v217
    v_and_b32 v21, 0xffff0000, v217
    v_lshlrev_b32 v22, 16, v209
    v_and_b32 v23, 0xffff0000, v209
    v_pk_mul_f32 v[20:21], v[20:21], v[22:23]
    v_cvt_pk_bf16_f32 v217, v20, v21
    v_lshlrev_b32 v8, 16, v218
    v_and_b32 v9, 0xffff0000, v218
    v_lshlrev_b32 v10, 16, v210
    v_and_b32 v11, 0xffff0000, v210
    v_pk_mul_f32 v[8:9], v[8:9], v[10:11]
    v_cvt_pk_bf16_f32 v218, v8, v9
    v_lshlrev_b32 v12, 16, v219
    v_and_b32 v13, 0xffff0000, v219
    v_lshlrev_b32 v14, 16, v211
    v_and_b32 v15, 0xffff0000, v211
    v_pk_mul_f32 v[12:13], v[12:13], v[14:15]
    v_cvt_pk_bf16_f32 v219, v12, v13
    v_lshlrev_b32 v16, 16, v220
    v_and_b32 v17, 0xffff0000, v220
    v_lshlrev_b32 v18, 16, v212
    v_and_b32 v19, 0xffff0000, v212
    v_pk_mul_f32 v[16:17], v[16:17], v[18:19]
    v_cvt_pk_bf16_f32 v220, v16, v17
    v_lshlrev_b32 v20, 16, v221
    v_and_b32 v21, 0xffff0000, v221
    v_lshlrev_b32 v22, 16, v213
    v_and_b32 v23, 0xffff0000, v213
    v_pk_mul_f32 v[20:21], v[20:21], v[22:23]
    v_cvt_pk_bf16_f32 v221, v20, v21
    v_dot2_f32_bf16 v222, v214, s31, 0
    v_dot2_f32_bf16 v223, v215, s31, 0
    v_dot2_f32_bf16 v222, v216, s31, v222
    v_dot2_f32_bf16 v223, v217, s31, v223
    v_dot2_f32_bf16 v222, v218, s31, v222
    v_dot2_f32_bf16 v223, v219, s31, v223
    v_dot2_f32_bf16 v222, v220, s31, v222
    v_dot2_f32_bf16 v223, v221, s31, v223
    s_nop 2
    v_add_f32 v222, v222, v223
    s_nop 1
    v_add_f32_dpp v222, v222, v222 row_shr:1 row_mask:0xf bank_mask:0xf bound_ctrl:1
    s_nop 1
    v_add_f32_dpp v222, v222, v222 row_shr:2 row_mask:0xf bank_mask:0xf bound_ctrl:1
    s_nop 1
    v_add_f32_dpp v222, v222, v222 row_shr:4 row_mask:0xf bank_mask:0xf bound_ctrl:1
    s_nop 1
    v_add_f32_dpp v222, v222, v222 row_shr:8 row_mask:0xf bank_mask:0xf bound_ctrl:1
    s_nop 1
    v_add_f32_dpp v222, v222, v222 row_bcast:15 row_mask:0xa bank_mask:0xf
    v_cvt_pk_bf16_f32 v223, v222, v222
    v_lshlrev_b32 v223, 16, v223
    v_mul_f32 v223, 0xbfb8aa3b, v223
    v_exp_f32 v223, v223
    s_nop 0
    v_add_f32 v223, 1.0, v223
    v_rcp_f32 v223, v223
    s_nop 0
    v_cvt_pk_bf16_f32 v223, v223, v223
    v_lshlrev_b32 v224, 16, v223
    v_sub_f32 v225, 1.0, v224
    v_cvt_pk_bf16_f32 v225, v225, v225
    v_lshlrev_b32 v225, 16, v225
    v_mul_f32 v224, 0x36000000, v224
    v_lshrrev_b32 v226, 5, v0
    v_and_b32 v228, 31, v0
    v_cmp_eq_u32 vcc, 31, v228
    v_lshlrev_b32 v226, 8, v226
    s_lshl_b32 s29, s4, 8
    s_add_u32 s29, s29, s5
    s_lshl_b32 s29, s29, 3
    s_add_u32 s29, s29, 131072
    s_and_saveexec_b64 s[48:49], vcc
    buffer_store_dwordx2 v[224:225], v226, s[24:27], s29 offen sc1
    s_mov_b64 exec, s[48:49]
    s_add_u32 s29, s5, 4
    s_and_b32 s29, s29, 31
    s_lshl_b32 s47, s4, 5
    s_add_u32 s47, s47, s29
    v_lshrrev_b32 v4, 1, v1
    v_and_b32 v5, 7, v4
    v_lshrrev_b32 v4, 3, v4
    v_lshl_add_u32 v4, v5, 3, v4
    v_mul_u32_u24 v4, 8320, v4
    v_and_b32 v5, 1, v1
    v_lshl_add_u32 v240, v5, 6, v4
    v_lshlrev_b32 v241, 4, v1
    s_lshl_b32 s29, s6, 6
    v_lshlrev_b32 v4, 2, v2
    v_lshl_add_u32 v4, v3, 10, v4
    v_add_u32 v248, s29, v4
    v_add_u32 v242, 26624, v248
    s_lshl_b32 s29, s6, 4
    v_add_u32 v4, s29, v2
    v_sub_u32 v5, 64, v4
    v_lshlrev_b32 v5, 2, v5
    v_lshlrev_b32 v6, 10, v3
    v_sub_u32 v6, 3072, v6
    v_add_u32 v249, v5, v6
    v_mul_u32_u24 v4, 72, v4
    v_lshl_add_u32 v243, v3, 3, v4
    v_lshrrev_b32 v4, 2, v2
    v_lshl_add_u32 v5, v3, 3, v4
    v_mul_u32_u24 v5, 72, v5
    v_and_b32 v6, 3, v2
    v_lshl_add_u32 v244, v6, 3, v5
    v_lshrrev_b32 v4, 3, v2
    v_lshlrev_b32 v4, 10, v4
    v_lshl_add_u32 v4, v3, 8, v4
    v_and_b32 v5, 7, v2
    v_lshl_add_u32 v245, v5, 5, v4
    s_mul_i32 s29, s6, 2560
    s_add_u32 s29, s29, 52224
    v_mul_u32_u24 v4, 80, v2
    v_lshl_add_u32 v4, v3, 3, v4
    v_add_u32 v246, s29, v4
    v_lshrrev_b32 v4, 2, v1
    v_mul_u32_u24 v4, 80, v4
    v_and_b32 v5, 3, v1
    v_lshl_add_u32 v4, v5, 4, v4
    v_add_u32 v247, s29, v4
    v_cvt_f32_u32 v4, v2
    v_lshlrev_b32 v5, 2, v3
    v_cvt_f32_u32 v5, v5
    v_mul_f32 v6, 0x3d000000, v4
    v_mul_f32 v8, v5, v6
    v_add_f32 v9, v8, v6
    v_add_f32 v10, v9, v6
    v_add_f32 v11, v10, v6
    v_cos_f32 v16, v8
    v_sin_f32 v20, v8
    v_cos_f32 v17, v9
    v_sin_f32 v21, v9
    v_cos_f32 v18, v10
    v_sin_f32 v22, v10
    v_cos_f32 v19, v11
    v_sin_f32 v23, v11
    v_cvt_pk_bf16_f32 v126, v16, v17
    v_cvt_pk_bf16_f32 v127, v18, v19
    v_cvt_pk_bf16_f32 v128, v20, v21
    v_cvt_pk_bf16_f32 v129, v22, v23
    v_cvt_pk_bf16_f32 v124, -v20, -v21
    v_cvt_pk_bf16_f32 v125, -v22, -v23
    v_mov_b32 v130, v126
    v_mov_b32 v131, v127
    v_mov_b32 v132, v124
    v_mov_b32 v133, v125
    s_mov_b32 s30, 0x80000000
    v_xor_b32 v134, v239, v124
    v_xor_b32 v135, v239, v125
    v_xor_b32 v136, v239, v126
    v_xor_b32 v137, v239, v127
    v_xor_b32 v138, v239, v128
    v_xor_b32 v139, v239, v129
    v_xor_b32 v140, v239, v130
    v_xor_b32 v141, v239, v131
    v_xor_b32 v142, v239, v132
    v_xor_b32 v143, v239, v133
    v_xor_b32 v144, s30, v124
    v_xor_b32 v145, s30, v125
    v_xor_b32 v146, s30, v126
    v_xor_b32 v147, s30, v127
    v_xor_b32 v148, s30, v128
    v_xor_b32 v149, s30, v129
    v_xor_b32 v150, s30, v130
    v_xor_b32 v151, s30, v131
    v_xor_b32 v152, s30, v132
    v_xor_b32 v153, s30, v133
    v_xor_b32 v154, v239, v144
    v_xor_b32 v155, v239, v145
    v_xor_b32 v156, v239, v146
    v_xor_b32 v157, v239, v147
    v_xor_b32 v158, v239, v148
    v_xor_b32 v159, v239, v149
    v_xor_b32 v160, v239, v150
    v_xor_b32 v161, v239, v151
    v_xor_b32 v162, v239, v152
    v_xor_b32 v163, v239, v153
    s_lshl_b32 s29, s6, 4
    v_add_u32 v6, s29, v2
    v_cvt_f32_u32 v6, v6
    v_mul_f32 v6, 0x3a000000, v6
    v_add_f32 v7, 0x00000000, v5
    v_mul_f32 v8, v7, v6
    v_add_f32 v9, v8, v6
    v_add_f32 v10, v9, v6
    v_add_f32 v11, v10, v6
    v_cos_f32 v188, v8
    v_sin_f32 v196, v8
    v_cos_f32 v189, v9
    v_sin_f32 v197, v9
    v_cos_f32 v190, v10
    v_sin_f32 v198, v10
    v_cos_f32 v191, v11
    v_sin_f32 v199, v11
    v_add_f32 v7, 0x41800000, v5
    v_mul_f32 v8, v7, v6
    v_add_f32 v9, v8, v6
    v_add_f32 v10, v9, v6
    v_add_f32 v11, v10, v6
    v_cos_f32 v192, v8
    v_sin_f32 v200, v8
    v_cos_f32 v193, v9
    v_sin_f32 v201, v9
    v_cos_f32 v194, v10
    v_sin_f32 v202, v10
    v_cos_f32 v195, v11
    v_sin_f32 v203, v11
    s_lshr_b32 s29, s3, 5
    s_lshl_b32 s29, s29, 6
    s_and_b32 s30, s3, 3
    s_lshl_b32 s30, s30, 4
    s_add_u32 s29, s29, s30
    v_lshrrev_b32 v4, 4, v0
    v_add_u32 v5, s29, v4
    s_lshr_b32 s31, s3, 2
    s_and_b32 s31, s31, 7
    s_lshl_b32 s42, s31, 5
    v_and_b32 v6, 15, v0
    v_lshlrev_b32 v7, 1, v6
    v_add_u32 v7, s42, v7
    v_mul_u32_u24 v8, v7, v5
    v_add_u32 v9, v8, v5
    v_and_b32 v8, 511, v8
    v_and_b32 v9, 511, v9
    v_lshlrev_b32 v10, 8, v5
    v_and_b32 v10, 511, v10
    v_cvt_f32_u32 v8, v8
    v_cvt_f32_u32 v9, v9
    v_cvt_f32_u32 v10, v10
    v_mul_f32 v8, 0x3b000000, v8
    v_mul_f32 v9, 0x3b000000, v9
    v_mul_f32 v10, 0x3b000000, v10
    v_cos_f32 v11, v8
    v_sin_f32 v12, v8
    v_cos_f32 v13, v9
    v_sin_f32 v14, v9
    v_cos_f32 v10, v10
    v_cmp_eq_u32 vcc, 0, v7
    v_sub_f32 v12, 0, v12
    s_nop 0
    v_cndmask_b32 v12, v12, v10, vcc
    v_cvt_pk_bf16_f32 v12, v11, v12
    v_cvt_pk_bf16_f32 v13, v13, -v14
    s_lshr_b32 s29, s3, 2
    s_lshl_b32 s29, s29, 13
    s_and_b32 s30, s3, 3
    s_lshl_b32 s30, s30, 11
    s_add_u32 s29, s29, s30
    s_add_u32 s29, s29, 10485760
    v_lshlrev_b32 v4, 7, v4
    v_lshl_add_u32 v4, v6, 3, v4
    buffer_store_dwordx2 v[12:13], v4, s[24:27], s29 offen sc1
    s_cmp_lg_u32 s6, 0
    s_cbranch_scc1 K_gw14
    s_cmp_eq_u32 s3, 255
    s_cbranch_scc0 K_gn15
    s_mov_b32 s29, 4096
    s_mov_b32 s30, 0
    s_mov_b32 s31, 32768
    v_lshlrev_b32 v14, 4, v1
    v_and_b32 v15, 31, v1
    v_lshlrev_b32 v15, 7, v15
K_ml16:
    buffer_load_dwordx4 v[16:19], v14, s[24:27], s29 offen sc0 sc1
    buffer_load_dword v20, v15, s[24:27], s31 offen sc0 sc1
    s_add_u32 s30, s30, 1
    s_waitcnt vmcnt(0)
    v_xor_b32 v16, s28, v16
    v_xor_b32 v17, s28, v17
    v_xor_b32 v18, s28, v18
    v_xor_b32 v19, s28, v19
    v_xor_b32 v20, s28, v20
    v_or3_b32 v16, v16, v17, v18
    v_or3_b32 v16, v16, v19, v20
    v_cmp_ne_u32 vcc, 0, v16
    s_nop 0
    s_cbranch_vccz K_md17
    s_cmp_ge_u32 s30, 32768
    s_cbranch_scc1 K_md17
    s_sleep 0
    s_branch K_ml16
K_md17:
    v_mov_b32 v14, s28
    v_lshlrev_b32 v15, 8, v1
    s_mov_b64 s[48:49], exec
    s_mov_b64 exec, 255
    s_mov_b32 s29, 24576
    buffer_store_dword v14, v15, s[24:27], s29 offen sc0 sc1
    s_mov_b64 exec, s[48:49]
    s_branch K_gw14
K_gn15:
    s_lshl_b32 s29, s4, 8
    s_add_u32 s29, s29, 24576
    s_mov_b32 s30, 0
    v_lshlrev_b32 v14, 2, v1
    v_cmp_gt_u32 s[48:49], 1, v1
K_pl18:
    buffer_load_dword v16, v14, s[24:27], s29 offen sc0 sc1
    s_add_u32 s30, s30, 1
    s_waitcnt vmcnt(0)
    v_cmp_ne_u32 vcc, s28, v16
    s_nop 0
    s_and_b64 vcc, vcc, s[48:49]
    s_cbranch_vccz K_pd19
    s_cmp_ge_u32 s30, 32768
    s_cbranch_scc1 K_pd19
    s_sleep 1
    s_branch K_pl18
K_pd19:
K_gw14:
    s_barrier
    s_setprio 3
    s_lshr_b32 s29, s6, 1
    s_lshl_b32 s29, s29, 7
    s_and_b32 s30, s6, 1
    s_lshl_b32 s30, s30, 2
    s_add_u32 s29, s29, s30
    s_mul_i32 s29, s29, 8320
    s_lshr_b32 s30, s47, 2
    s_lshl_b32 s30, s30, 7
    s_add_u32 s29, s29, s30
    s_and_b32 s30, s47, 3
    s_lshl_b32 s30, s30, 4
    s_add_u32 s29, s29, s30
    s_add_u32 s29, s29, 1048576
    s_add_u32 s30, s29, 532480
    s_lshl_b32 s31, s6, 11
    s_add_u32 m0, s31, 18432
    s_cmp_eq_u32 s47, 0
    s_cselect_b32 s42, 256, s47
    buffer_load_dwordx4 v240, s[24:27], s29 offen sc1 lds
    s_add_u32 m0, m0, 1024
    s_mul_i32 s42, s42, 8320
    s_add_u32 s42, s42, s31
    buffer_load_dwordx4 v240, s[24:27], s30 offen sc1 lds
    s_add_u32 m0, s31, 26624
    s_add_u32 s42, s42, 4194304
    buffer_load_dwordx4 v241, s[24:27], s42 offen sc1 lds
    s_cmp_lg_u32 s47, 0
    buffer_load_dwordx4 v241, s[24:27], s42 offen offset:1024 sc1 lds
    s_cbranch_scc1 K_cl20
    s_add_u32 m0, s31, 44032
    s_add_u32 s42, s42, 8320
    buffer_load_dwordx4 v241, s[24:27], s42 offen sc1 lds
    buffer_load_dwordx4 v241, s[24:27], s42 offen offset:1024 sc1 lds
K_cl20:
    s_waitcnt vmcnt(0)
    s_barrier
    ds_read_b128 v[8:11], v245 offset:18432
    ds_read_b128 v[12:15], v245 offset:18448
    ds_read_b128 v[16:19], v245 offset:20480
    ds_read_b128 v[20:23], v245 offset:20496
    ds_read_b128 v[24:27], v245 offset:22528
    ds_read_b128 v[28:31], v245 offset:22544
    ds_read_b128 v[32:35], v245 offset:24576
    ds_read_b128 v[36:39], v245 offset:24592
    ds_read2st64_b32 v[92:93], v242 offset0:0 offset1:1
    ds_read2st64_b32 v[94:95], v242 offset0:2 offset1:3
    ds_read2st64_b32 v[96:97], v242 offset0:16 offset1:17
    ds_read2st64_b32 v[98:99], v242 offset0:18 offset1:19
    s_waitcnt lgkmcnt(8)
    v_mfma_f32_16x16x32_bf16 v[40:43], v[8:11], v[100:103], 0
    v_mfma_f32_16x16x32_bf16 v[44:47], v[12:15], v[100:103], 0
    v_mfma_f32_16x16x32_bf16 v[40:43], v[16:19], v[104:107], v[40:43]
    v_mfma_f32_16x16x32_bf16 v[44:47], v[20:23], v[104:107], v[44:47]
    v_mfma_f32_16x16x32_bf16 v[40:43], v[12:15], v[108:111], v[40:43]
    v_mfma_f32_16x16x32_bf16 v[44:47], v[8:11], v[116:119], v[44:47]
    v_mfma_f32_16x16x32_bf16 v[40:43], v[20:23], v[112:115], v[40:43]
    v_mfma_f32_16x16x32_bf16 v[44:47], v[16:19], v[120:123], v[44:47]
    s_waitcnt lgkmcnt(4)
    v_mfma_f32_16x16x32_bf16 v[48:51], v[24:27], v[100:103], 0
    v_mfma_f32_16x16x32_bf16 v[52:55], v[28:31], v[100:103], 0
    v_mfma_f32_16x16x32_bf16 v[48:51], v[32:35], v[104:107], v[48:51]
    v_mfma_f32_16x16x32_bf16 v[52:55], v[36:39], v[104:107], v[52:55]
    v_mfma_f32_16x16x32_bf16 v[48:51], v[28:31], v[108:111], v[48:51]
    v_mfma_f32_16x16x32_bf16 v[52:55], v[24:27], v[116:119], v[52:55]
    v_mfma_f32_16x16x32_bf16 v[48:51], v[36:39], v[112:115], v[48:51]
    v_mfma_f32_16x16x32_bf16 v[52:55], v[32:35], v[120:123], v[52:55]
    v_pk_mul_f32 v[56:57], v[40:41], v[188:189]
    v_pk_mul_f32 v[58:59], v[44:45], v[188:189]
    v_pk_fma_f32 v[60:61], v[44:45], v[196:197], v[56:57]
    v_pk_fma_f32 v[64:65], v[40:41], v[196:197], v[58:59] neg_lo:[1,0,0] neg_hi:[1,0,0]
    v_pk_mul_f32 v[56:57], v[42:43], v[190:191]
    v_pk_mul_f32 v[58:59], v[46:47], v[190:191]
    v_pk_fma_f32 v[62:63], v[46:47], v[198:199], v[56:57]
    v_pk_fma_f32 v[66:67], v[42:43], v[198:199], v[58:59] neg_lo:[1,0,0] neg_hi:[1,0,0]
    v_cvt_pk_bf16_f32 v68, v60, v61
    v_cvt_pk_bf16_f32 v69, v62, v63
    v_cvt_pk_bf16_f32 v70, v64, v65
    v_cvt_pk_bf16_f32 v71, v66, v67
    v_pk_mul_f32 v[56:57], v[48:49], v[192:193]
    v_pk_mul_f32 v[58:59], v[52:53], v[192:193]
    v_pk_fma_f32 v[60:61], v[52:53], v[200:201], v[56:57]
    v_pk_fma_f32 v[64:65], v[48:49], v[200:201], v[58:59] neg_lo:[1,0,0] neg_hi:[1,0,0]
    v_pk_mul_f32 v[56:57], v[50:51], v[194:195]
    v_pk_mul_f32 v[58:59], v[54:55], v[194:195]
    v_pk_fma_f32 v[62:63], v[54:55], v[202:203], v[56:57]
    v_pk_fma_f32 v[66:67], v[50:51], v[202:203], v[58:59] neg_lo:[1,0,0] neg_hi:[1,0,0]
    v_cvt_pk_bf16_f32 v72, v60, v61
    v_cvt_pk_bf16_f32 v73, v62, v63
    v_cvt_pk_bf16_f32 v74, v64, v65
    v_cvt_pk_bf16_f32 v75, v66, v67
    v_mfma_f32_16x16x32_bf16 v[76:79], v[126:129], v[68:71], 0
    v_mfma_f32_16x16x32_bf16 v[80:83], v[124:127], v[68:71], 0
    v_mfma_f32_16x16x32_bf16 v[76:79], v[136:139], v[72:75], v[76:79]
    v_mfma_f32_16x16x32_bf16 v[80:83], v[134:137], v[72:75], v[80:83]
    v_mfma_f32_16x16x32_bf16 v[84:87], v[146:149], v[68:71], 0
    v_mfma_f32_16x16x32_bf16 v[88:91], v[144:147], v[68:71], 0
    v_mfma_f32_16x16x32_bf16 v[84:87], v[156:159], v[72:75], v[84:87]
    v_mfma_f32_16x16x32_bf16 v[88:91], v[154:157], v[72:75], v[88:91]
    s_waitcnt lgkmcnt(0)
    v_lshlrev_b32 v8, 16, v92
    v_and_b32 v16, 0xffff0000, v92
    v_lshlrev_b32 v9, 16, v93
    v_and_b32 v17, 0xffff0000, v93
    v_lshlrev_b32 v10, 16, v94
    v_and_b32 v18, 0xffff0000, v94
    v_lshlrev_b32 v11, 16, v95
    v_and_b32 v19, 0xffff0000, v95
    v_lshlrev_b32 v12, 16, v96
    v_and_b32 v20, 0xffff0000, v96
    v_lshlrev_b32 v13, 16, v97
    v_and_b32 v21, 0xffff0000, v97
    v_lshlrev_b32 v14, 16, v98
    v_and_b32 v22, 0xffff0000, v98
    v_lshlrev_b32 v15, 16, v99
    v_and_b32 v23, 0xffff0000, v99
    s_cmp_eq_u32 s47, 0
    s_cbranch_scc1 K_sp21
    v_pk_mul_f32 v[56:57], v[76:77], v[8:9]
    v_pk_mul_f32 v[58:59], v[80:81], v[8:9]
    v_pk_fma_f32 v[60:61], v[80:81], v[16:17], v[56:57] neg_lo:[1,0,0] neg_hi:[1,0,0]
    v_pk_fma_f32 v[64:65], v[76:77], v[16:17], v[58:59]
    v_pk_mul_f32 v[56:57], v[78:79], v[10:11]
    v_pk_mul_f32 v[58:59], v[82:83], v[10:11]
    v_pk_fma_f32 v[62:63], v[82:83], v[18:19], v[56:57] neg_lo:[1,0,0] neg_hi:[1,0,0]
    v_pk_fma_f32 v[66:67], v[78:79], v[18:19], v[58:59]
    v_cvt_pk_bf16_f32 v68, v60, v61
    v_cvt_pk_bf16_f32 v69, v62, v63
    v_cvt_pk_bf16_f32 v70, v64, v65
    v_cvt_pk_bf16_f32 v71, v66, v67
    v_pk_mul_f32 v[56:57], v[84:85], v[12:13]
    v_pk_mul_f32 v[58:59], v[88:89], v[12:13]
    v_pk_fma_f32 v[60:61], v[88:89], v[20:21], v[56:57] neg_lo:[1,0,0] neg_hi:[1,0,0]
    v_pk_fma_f32 v[64:65], v[84:85], v[20:21], v[58:59]
    v_pk_mul_f32 v[56:57], v[86:87], v[14:15]
    v_pk_mul_f32 v[58:59], v[90:91], v[14:15]
    v_pk_fma_f32 v[62:63], v[90:91], v[22:23], v[56:57] neg_lo:[1,0,0] neg_hi:[1,0,0]
    v_pk_fma_f32 v[66:67], v[86:87], v[22:23], v[58:59]
    v_cvt_pk_bf16_f32 v72, v60, v61
    v_cvt_pk_bf16_f32 v73, v62, v63
    v_cvt_pk_bf16_f32 v74, v64, v65
    v_cvt_pk_bf16_f32 v75, v66, v67
    s_branch K_jn22
K_sp21:
    ds_write2st64_b32 v248, v76, v80 offset0:0 offset1:33
    ds_write2st64_b32 v248, v77, v81 offset0:1 offset1:34
    ds_write2st64_b32 v248, v78, v82 offset0:2 offset1:35
    ds_write2st64_b32 v248, v79, v83 offset0:3 offset1:36
    ds_write2st64_b32 v248, v84, v88 offset0:16 offset1:49
    ds_write2st64_b32 v248, v85, v89 offset0:17 offset1:50
    ds_write2st64_b32 v248, v86, v90 offset0:18 offset1:51
    ds_write2st64_b32 v248, v87, v91 offset0:19 offset1:52
    s_cmp_eq_u32 s6, 0
    s_cselect_b32 s29, 1, 0
    v_cmp_gt_u32 vcc, s29, v1
    s_nop 0
    s_and_saveexec_b64 s[48:49], vcc
    ds_write2st64_b32 v248, v76, v80 offset0:32 offset1:65
    s_mov_b64 exec, s[48:49]
    v_add_u32 v4, 17408, v242
    ds_read2st64_b32 v[92:93], v4 offset0:0 offset1:1
    ds_read2st64_b32 v[94:95], v4 offset0:2 offset1:3
    ds_read2st64_b32 v[96:97], v4 offset0:16 offset1:17
    ds_read2st64_b32 v[98:99], v4 offset0:18 offset1:19
    s_waitcnt lgkmcnt(0)
    s_barrier
    ds_read2st64_b32 v[24:25], v249 offset0:19 offset1:18
    ds_read2st64_b32 v[32:33], v249 offset0:52 offset1:51
    ds_read2st64_b32 v[26:27], v249 offset0:17 offset1:16
    ds_read2st64_b32 v[34:35], v249 offset0:50 offset1:49
    ds_read2st64_b32 v[28:29], v249 offset0:3 offset1:2
    ds_read2st64_b32 v[36:37], v249 offset0:36 offset1:35
    ds_read2st64_b32 v[30:31], v249 offset0:1 offset1:0
    ds_read2st64_b32 v[38:39], v249 offset0:34 offset1:33
    v_lshlrev_b32 v40, 16, v92
    v_and_b32 v48, 0xffff0000, v92
    v_lshlrev_b32 v41, 16, v93
    v_and_b32 v49, 0xffff0000, v93
    v_lshlrev_b32 v42, 16, v94
    v_and_b32 v50, 0xffff0000, v94
    v_lshlrev_b32 v43, 16, v95
    v_and_b32 v51, 0xffff0000, v95
    v_lshlrev_b32 v44, 16, v96
    v_and_b32 v52, 0xffff0000, v96
    v_lshlrev_b32 v45, 16, v97
    v_and_b32 v53, 0xffff0000, v97
    v_lshlrev_b32 v46, 16, v98
    v_and_b32 v54, 0xffff0000, v98
    v_lshlrev_b32 v47, 16, v99
    v_and_b32 v55, 0xffff0000, v99
    s_waitcnt lgkmcnt(0)
    v_pk_mul_f32 v[56:57], v[76:77], v[8:9]
    v_pk_mul_f32 v[58:59], v[80:81], v[8:9]
    v_pk_fma_f32 v[60:61], v[80:81], v[16:17], v[56:57] neg_lo:[1,0,0] neg_hi:[1,0,0]
    v_pk_fma_f32 v[64:65], v[76:77], v[16:17], v[58:59]
    v_pk_fma_f32 v[60:61], v[40:41], v[24:25], v[60:61]
    v_pk_fma_f32 v[64:65], v[48:49], v[24:25], v[64:65]
    v_pk_fma_f32 v[60:61], v[48:49], v[32:33], v[60:61]
    v_pk_fma_f32 v[64:65], v[40:41], v[32:33], v[64:65] neg_lo:[1,0,0] neg_hi:[1,0,0]
    v_pk_mul_f32 v[56:57], v[78:79], v[10:11]
    v_pk_mul_f32 v[58:59], v[82:83], v[10:11]
    v_pk_fma_f32 v[62:63], v[82:83], v[18:19], v[56:57] neg_lo:[1,0,0] neg_hi:[1,0,0]
    v_pk_fma_f32 v[66:67], v[78:79], v[18:19], v[58:59]
    v_pk_fma_f32 v[62:63], v[42:43], v[26:27], v[62:63]
    v_pk_fma_f32 v[66:67], v[50:51], v[26:27], v[66:67]
    v_pk_fma_f32 v[62:63], v[50:51], v[34:35], v[62:63]
    v_pk_fma_f32 v[66:67], v[42:43], v[34:35], v[66:67] neg_lo:[1,0,0] neg_hi:[1,0,0]
    v_cvt_pk_bf16_f32 v68, v60, v61
    v_cvt_pk_bf16_f32 v69, v62, v63
    v_cvt_pk_bf16_f32 v70, v64, v65
    v_cvt_pk_bf16_f32 v71, v66, v67
    v_pk_mul_f32 v[56:57], v[84:85], v[12:13]
    v_pk_mul_f32 v[58:59], v[88:89], v[12:13]
    v_pk_fma_f32 v[60:61], v[88:89], v[20:21], v[56:57] neg_lo:[1,0,0] neg_hi:[1,0,0]
    v_pk_fma_f32 v[64:65], v[84:85], v[20:21], v[58:59]
    v_pk_fma_f32 v[60:61], v[44:45], v[28:29], v[60:61]
    v_pk_fma_f32 v[64:65], v[52:53], v[28:29], v[64:65]
    v_pk_fma_f32 v[60:61], v[52:53], v[36:37], v[60:61]
    v_pk_fma_f32 v[64:65], v[44:45], v[36:37], v[64:65] neg_lo:[1,0,0] neg_hi:[1,0,0]
    v_pk_mul_f32 v[56:57], v[86:87], v[14:15]
    v_pk_mul_f32 v[58:59], v[90:91], v[14:15]
    v_pk_fma_f32 v[62:63], v[90:91], v[22:23], v[56:57] neg_lo:[1,0,0] neg_hi:[1,0,0]
    v_pk_fma_f32 v[66:67], v[86:87], v[22:23], v[58:59]
    v_pk_fma_f32 v[62:63], v[46:47], v[30:31], v[62:63]
    v_pk_fma_f32 v[66:67], v[54:55], v[30:31], v[66:67]
    v_pk_fma_f32 v[62:63], v[54:55], v[38:39], v[62:63]
    v_pk_fma_f32 v[66:67], v[46:47], v[38:39], v[66:67] neg_lo:[1,0,0] neg_hi:[1,0,0]
    v_cvt_pk_bf16_f32 v72, v60, v61
    v_cvt_pk_bf16_f32 v73, v62, v63
    v_cvt_pk_bf16_f32 v74, v64, v65
    v_cvt_pk_bf16_f32 v75, v66, v67
K_jn22:
    v_mfma_f32_16x16x32_bf16 v[40:43], v[130:133], v[68:71], 0
    v_mfma_f32_16x16x32_bf16 v[44:47], v[128:131], v[68:71], 0
    v_mfma_f32_16x16x32_bf16 v[40:43], v[140:143], v[72:75], v[40:43]
    v_mfma_f32_16x16x32_bf16 v[44:47], v[138:141], v[72:75], v[44:47]
    v_mfma_f32_16x16x32_bf16 v[48:51], v[150:153], v[68:71], 0
    v_mfma_f32_16x16x32_bf16 v[52:55], v[148:151], v[68:71], 0
    v_mfma_f32_16x16x32_bf16 v[48:51], v[160:163], v[72:75], v[48:51]
    v_mfma_f32_16x16x32_bf16 v[52:55], v[158:161], v[72:75], v[52:55]
    s_nop 2
    v_pk_mul_f32 v[56:57], v[40:41], v[188:189]
    v_pk_mul_f32 v[58:59], v[44:45], v[188:189]
    v_pk_fma_f32 v[60:61], v[44:45], v[196:197], v[56:57] neg_lo:[1,0,0] neg_hi:[1,0,0]
    v_pk_fma_f32 v[64:65], v[40:41], v[196:197], v[58:59]
    v_pk_mul_f32 v[56:57], v[42:43], v[190:191]
    v_pk_mul_f32 v[58:59], v[46:47], v[190:191]
    v_pk_fma_f32 v[62:63], v[46:47], v[198:199], v[56:57] neg_lo:[1,0,0] neg_hi:[1,0,0]
    v_pk_fma_f32 v[66:67], v[42:43], v[198:199], v[58:59]
    v_cvt_pk_bf16_f32 v68, v60, v61
    v_cvt_pk_bf16_f32 v69, v62, v63
    v_cvt_pk_bf16_f32 v70, v64, v65
    v_cvt_pk_bf16_f32 v71, v66, v67
    ds_write_b64 v243, v[68:69] offset:34816
    ds_write_b64 v243, v[70:71] offset:39424
    v_pk_mul_f32 v[56:57], v[48:49], v[192:193]
    v_pk_mul_f32 v[58:59], v[52:53], v[192:193]
    v_pk_fma_f32 v[60:61], v[52:53], v[200:201], v[56:57] neg_lo:[1,0,0] neg_hi:[1,0,0]
    v_pk_fma_f32 v[64:65], v[48:49], v[200:201], v[58:59]
    v_pk_mul_f32 v[56:57], v[50:51], v[194:195]
    v_pk_mul_f32 v[58:59], v[54:55], v[194:195]
    v_pk_fma_f32 v[62:63], v[54:55], v[202:203], v[56:57] neg_lo:[1,0,0] neg_hi:[1,0,0]
    v_pk_fma_f32 v[66:67], v[50:51], v[202:203], v[58:59]
    v_cvt_pk_bf16_f32 v72, v60, v61
    v_cvt_pk_bf16_f32 v73, v62, v63
    v_cvt_pk_bf16_f32 v74, v64, v65
    v_cvt_pk_bf16_f32 v75, v66, v67
    ds_write_b64 v243, v[72:73] offset:34848
    ds_write_b64 v243, v[74:75] offset:39456
    s_waitcnt lgkmcnt(0)
    s_barrier
    ds_read_b64_tr_b16 v[8:9], v244 offset:34816
    ds_read_b64_tr_b16 v[10:11], v244 offset:35104
    ds_read_b64_tr_b16 v[12:13], v244 offset:39424
    ds_read_b64_tr_b16 v[14:15], v244 offset:39712
    ds_read_b64_tr_b16 v[16:17], v244 offset:37120
    ds_read_b64_tr_b16 v[18:19], v244 offset:37408
    ds_read_b64_tr_b16 v[20:21], v244 offset:41728
    ds_read_b64_tr_b16 v[22:23], v244 offset:42016
    ds_read_b64_tr_b16 v[24:25], v244 offset:34848
    ds_read_b64_tr_b16 v[26:27], v244 offset:35136
    ds_read_b64_tr_b16 v[28:29], v244 offset:39456
    ds_read_b64_tr_b16 v[30:31], v244 offset:39744
    ds_read_b64_tr_b16 v[32:33], v244 offset:37152
    ds_read_b64_tr_b16 v[34:35], v244 offset:37440
    ds_read_b64_tr_b16 v[36:37], v244 offset:41760
    ds_read_b64_tr_b16 v[38:39], v244 offset:42048
    s_mul_i32 s29, s47, 8320
    s_lshl_b32 s30, s6, 10
    s_add_u32 s29, s29, s30
    s_add_u32 s29, s29, 7340032
    s_add_u32 s30, s29, 4096
    s_waitcnt lgkmcnt(8)
    v_mfma_f32_16x16x32_bf16 v[76:79], v[8:11], v[100:103], 0
    v_mfma_f32_16x16x32_bf16 v[80:83], v[8:11], v[108:111], 0
    v_mfma_f32_16x16x32_bf16 v[76:79], v[16:19], v[104:107], v[76:79]
    v_mfma_f32_16x16x32_bf16 v[80:83], v[16:19], v[112:115], v[80:83]
    v_mfma_f32_16x16x32_bf16 v[76:79], v[12:15], v[116:119], v[76:79]
    v_mfma_f32_16x16x32_bf16 v[80:83], v[12:15], v[100:103], v[80:83]
    v_mfma_f32_16x16x32_bf16 v[76:79], v[20:23], v[120:123], v[76:79]
    v_mfma_f32_16x16x32_bf16 v[80:83], v[20:23], v[104:107], v[80:83]
    s_waitcnt lgkmcnt(0)
    v_mfma_f32_16x16x32_bf16 v[84:87], v[24:27], v[100:103], 0
    v_mfma_f32_16x16x32_bf16 v[88:91], v[24:27], v[108:111], 0
    v_mfma_f32_16x16x32_bf16 v[84:87], v[32:35], v[104:107], v[84:87]
    v_mfma_f32_16x16x32_bf16 v[88:91], v[32:35], v[112:115], v[88:91]
    v_mfma_f32_16x16x32_bf16 v[84:87], v[28:31], v[116:119], v[84:87]
    v_mfma_f32_16x16x32_bf16 v[88:91], v[28:31], v[100:103], v[88:91]
    v_mfma_f32_16x16x32_bf16 v[84:87], v[36:39], v[120:123], v[84:87]
    v_mfma_f32_16x16x32_bf16 v[88:91], v[36:39], v[104:107], v[88:91]
    v_cvt_pk_bf16_f32 v56, v76, v77
    v_cvt_pk_bf16_f32 v57, v78, v79
    v_cvt_pk_bf16_f32 v58, v80, v81
    v_cvt_pk_bf16_f32 v59, v82, v83
    ds_write_b64 v246, v[56:57] offset:0
    ds_write_b64 v246, v[58:59] offset:1280
    s_nop 0
    v_cvt_pk_bf16_f32 v60, v84, v85
    v_cvt_pk_bf16_f32 v61, v86, v87
    v_cvt_pk_bf16_f32 v62, v88, v89
    v_cvt_pk_bf16_f32 v63, v90, v91
    ds_write_b64 v246, v[60:61] offset:32
    ds_write_b64 v246, v[62:63] offset:1312
    s_waitcnt lgkmcnt(0)
    ds_read_b128 v[8:11], v247
    ds_read_b128 v[12:15], v247 offset:1280
    s_waitcnt lgkmcnt(1)
    buffer_store_dwordx4 v[8:11], v241, s[24:27], s29 offen sc1
    s_waitcnt lgkmcnt(0)
    buffer_store_dwordx4 v[12:15], v241, s[24:27], s30 offen sc1
    s_waitcnt vmcnt(0)
    s_barrier
    s_cmp_eq_u32 s6, 0
    s_cselect_b32 s30, 0, 0x7ff00000
    s_lshl_b32 s29, s3, 2
    s_add_u32 s29, s29, 8192
    v_mov_b32 v14, s28
    v_mov_b32 v15, s30
    s_mov_b64 s[48:49], exec
    s_mov_b64 exec, 1
    buffer_store_dword v14, v15, s[24:27], s29 offen sc0 sc1
    s_mov_b64 exec, s[48:49]
    s_cmp_lg_u32 s6, 0
    s_cbranch_scc1 K_gc23
    s_cmp_lg_u32 s3, 255
    s_cbranch_scc1 K_gc23
    s_mov_b32 s29, 8192
    s_mov_b32 s30, 0
    v_lshlrev_b32 v14, 4, v1
K_pl24:
    buffer_load_dwordx4 v[16:19], v14, s[24:27], s29 offen sc0 sc1
    s_add_u32 s30, s30, 1
    s_waitcnt vmcnt(0)
    v_xor_b32 v16, s28, v16
    v_xor_b32 v17, s28, v17
    v_xor_b32 v18, s28, v18
    v_xor_b32 v19, s28, v19
    v_or3_b32 v16, v16, v17, v18
    v_or_b32 v16, v16, v19
    v_cmp_ne_u32 vcc, 0, v16
    s_nop 0
    s_cbranch_vccz K_pd25
    s_cmp_ge_u32 s30, 32768
    s_cbranch_scc1 K_pd25
    s_sleep 2
    s_branch K_pl24
K_pd25:
    v_mov_b32 v14, s28
    v_lshlrev_b32 v15, 8, v1
    s_mov_b64 s[48:49], exec
    s_mov_b64 exec, 255
    s_mov_b32 s29, 26624
    buffer_store_dword v14, v15, s[24:27], s29 offen sc0 sc1
    s_mov_b64 exec, s[48:49]
    v_lshlrev_b32 v14, 7, v1
    s_mov_b32 s30, 0
K_el26:
    s_mov_b32 s31, 98304
    buffer_load_dword v16, v14, s[24:27], s31 offen sc0 sc1
    s_mov_b32 s31, 106496
    buffer_load_dword v17, v14, s[24:27], s31 offen sc0 sc1
    s_mov_b32 s31, 114688
    buffer_load_dword v18, v14, s[24:27], s31 offen sc0 sc1
    s_mov_b32 s31, 122880
    buffer_load_dword v19, v14, s[24:27], s31 offen sc0 sc1
    s_add_u32 s30, s30, 1
    s_waitcnt vmcnt(0)
    v_xor_b32 v16, s28, v16
    v_xor_b32 v17, s28, v17
    v_xor_b32 v18, s28, v18
    v_xor_b32 v19, s28, v19
    v_or3_b32 v16, v16, v17, v18
    v_or_b32 v16, v16, v19
    v_cmp_ne_u32 vcc, 0, v16
    s_nop 0
    s_cbranch_vccz K_ed27
    s_cmp_ge_u32 s30, 32768
    s_cbranch_scc1 K_ed27
    s_sleep 8
    s_branch K_el26
K_ed27:
    v_mov_b32 v14, s28
    v_mov_b32 v15, 0
    s_mov_b64 exec, 1
    buffer_store_dword v14, v15, s[24:27], 0 offen sc0 sc1
    s_mov_b64 exec, -1
K_gc23:
K_end:
    s_endpgm
.section .rodata,"a"
.p2align 6
.amdhsa_kernel gated_mix__spectral_gfnet__dense_activation_mish__prompt_kernel
  .amdhsa_next_free_vgpr 256
  .amdhsa_next_free_sgpr 102
  .amdhsa_accum_offset 256
  .amdhsa_group_segment_fixed_size 0
  .amdhsa_kernarg_size 88
  .amdhsa_user_sgpr_count 2
  .amdhsa_user_sgpr_kernarg_segment_ptr 1
  .amdhsa_system_sgpr_workgroup_id_x 1
  .amdhsa_float_denorm_mode_32 3
.end_amdhsa_kernel
```
